```python
import torch

def _softmax(x, axis=-1):
    return torch.softmax(x, dim=axis)
def _gelu(x):
    return torch.nn.functional.gelu(x, approximate="tanh")
def _silu(x):
    return torch.nn.functional.silu(x)
def _sigmoid(x):
    return torch.sigmoid(x)
def _layernorm(x, axis=-1, eps=1e-5):
    m = x.mean(dim=axis, keepdim=True)
    v = x.var(dim=axis, keepdim=True, unbiased=False)
    return (x - m) / torch.sqrt(v + eps)
def _scatter_add(tgt, idx, src, axis=0):
    return tgt.clone().index_add_(axis, idx, src)
def _segment_sum(src, seg, n):
    out = torch.zeros((n,) + src.shape[1:], dtype=src.dtype)
    return out.index_add_(0, seg, src)
def _pad(x, pw):
    flat = tuple(v for pair in reversed(pw) for v in pair)
    return torch.nn.functional.pad(x, flat)

kernel_name = 'standalone__sliding_block_cached__sampling'

def setup_inputs():

    _w = (lambda a: (lambda t: t.to(torch.bfloat16) if t.is_floating_point() else t)(torch.as_tensor(a)))
    B, Sq, D = 32, 1, 1024
    Hq, Hkv, Sk, Dh = 32, 4, 2048, 128
    assert Hq % Hkv == 0, (Hq, Hkv)
    return {
        "x": _w((lambda *s: torch.randn(*s, dtype=torch.bfloat16) * 0.8)(B, Sq, D)),
        "k_cache": _w((lambda *s: torch.randn(*s, dtype=torch.bfloat16) * 0.8)(B, Hkv, Sk, Dh)),
        "v_cache": _w((lambda *s: torch.randn(*s, dtype=torch.bfloat16) * 0.05)(B, Hkv, Sk, Dh)),
        "wq": _w((lambda *s: torch.randn(*s, dtype=torch.bfloat16) * 0.8)(D, Hq * Dh) * (D ** -0.5)),
        "wo": _w((lambda *s: torch.randn(*s, dtype=torch.bfloat16) * 0.05)(Hq * Dh, D) * ((Hq * Dh) ** -0.5)),
    }

def reference(x, k_cache, v_cache, wq, wo):
    B, Sq, D = x.shape
    Hq, Dh = 32, 128
    Hkv, Sk = k_cache.shape[1], k_cache.shape[2]
    W = min(4096, max(256, Sk // 4))
    rep = Hq // Hkv
    q = (lambda x, *d: x.permute(*d))((x @ wq).reshape(B, Sq, Hq, Dh), 0, 2, 1, 3)
    k = (lambda x, n, axis: torch.repeat_interleave(x, n, dim=axis))(k_cache[:, :, Sk - W:, :], rep, axis=1)
    v = (lambda x, n, axis: torch.repeat_interleave(x, n, dim=axis))(v_cache[:, :, Sk - W:, :], rep, axis=1)
    scores = torch.einsum("bhqd,bhkd->bhqk", q, k) * (Dh ** -0.5)
    p = _softmax(scores, axis=-1)
    o = torch.einsum("bhqk,bhkd->bhqd", p, v)
    return (lambda x, *d: x.permute(*d))(o, 0, 2, 1, 3).reshape(B, Sq, Hq * Dh) @ wo
```

```asm
; @launch grid=(256,1,1) block=(576,1,1) lds=163840
.amdgcn_target "amdgcn-amd-amdhsa--gfx950"
.text
.globl standalone__sliding_block_cached__sampling_kernel
.p2align 8
.type standalone__sliding_block_cached__sampling_kernel,@function
standalone__sliding_block_cached__sampling_kernel:
    s_cmp_ge_u32 s2, 256
    s_cbranch_scc1 L_end
    s_load_dwordx4 s[4:7], s[0:1], 0
    s_load_dwordx4 s[8:11], s[0:1], 16
    s_load_dwordx4 s[12:15], s[0:1], 32
    s_load_dwordx2 s[16:17], s[0:1], 56
    v_lshrrev_b32 v1, 6, v0
    s_nop 0
    v_readfirstlane_b32 s3, v1
    v_and_b32 v1, 63, v0
    v_and_b32 v2, 15, v1
    v_lshrrev_b32 v3, 4, v1
    s_cmp_ge_u32 s2, 128
    s_cbranch_scc1 L_attn
    v_lshrrev_b32 v4, 3, v1
    v_and_b32 v5, 7, v1
    v_bfe_u32 v6, v1, 4, 1
    v_lshlrev_b32 v6, 1, v6
    v_xor_b32 v6, v6, v5
    v_lshlrev_b32 v6, 4, v6
    s_and_b32 s37, s2, 7
    s_lshr_b32 s61, s2, 3
    s_and_b32 s62, s61, 1
    s_lshr_b32 s63, s61, 1
    s_add_u32 s36, s37, s63
    s_and_b32 s36, s36, 7
    s_lshl_b32 s63, s63, 3
    s_add_u32 s63, s63, s36
    s_cmp_ge_u32 s3, 8
    s_cbranch_scc1 L_help
    v_lshl_add_u32 v16, v4, 13, v6
    v_xor_b32 v17, 64, v16
    s_lshr_b32 s18, s3, 2
    s_and_b32 s19, s3, 3
    s_lshl_b32 s43, s3, 12
    s_add_u32 s43, s43, 131072
    s_mov_b32 s51, s62
    s_mov_b32 s52, s63
    s_lshl_b32 s39, s51, 9
    s_lshl_b32 s36, s3, 6
    s_add_u32 s39, s39, s36
    s_lshl_b32 s39, s39, 13
    s_lshl_b32 s36, s52, 7
    s_add_u32 s39, s39, s36
    s_lshl_b32 s42, s3, 13
    s_waitcnt lgkmcnt(0)
    s_mov_b32 s20, s10
    s_and_b32 s21, s11, 0xffff
    s_mov_b32 s22, 8388608
    s_mov_b32 s23, 0x00020000
    s_add_u32 m0, s42, 0
    s_nop 0
    buffer_load_dwordx4 v16, s[20:23], s39 offen nt lds
    s_add_u32 m0, s42, 1024
    s_add_u32 s39, s39, 65536
    buffer_load_dwordx4 v17, s[20:23], s39 offen nt lds
    s_add_u32 m0, s42, 2048
    s_add_u32 s39, s39, 65536
    buffer_load_dwordx4 v16, s[20:23], s39 offen nt lds
    s_add_u32 m0, s42, 3072
    s_add_u32 s39, s39, 65536
    buffer_load_dwordx4 v17, s[20:23], s39 offen nt lds
    s_add_u32 m0, s42, 4096
    s_add_u32 s39, s39, 65536
    buffer_load_dwordx4 v16, s[20:23], s39 offen nt lds
    s_add_u32 m0, s42, 5120
    s_add_u32 s39, s39, 65536
    buffer_load_dwordx4 v17, s[20:23], s39 offen nt lds
    s_add_u32 m0, s42, 6144
    s_add_u32 s39, s39, 65536
    buffer_load_dwordx4 v16, s[20:23], s39 offen nt lds
    s_add_u32 m0, s42, 7168
    s_add_u32 s39, s39, 65536
    buffer_load_dwordx4 v17, s[20:23], s39 offen nt lds
    s_mov_b32 s28, s16
    s_and_b32 s29, s17, 0xffff
    s_mov_b32 s30, 268435456
    s_mov_b32 s31, 0x00020000
    s_mov_b32 s32, s4
    s_and_b32 s33, s5, 0xffff
    s_mov_b32 s34, 65536
    s_mov_b32 s35, 0x00020000
    v_lshlrev_b32 v10, 1, v3
    v_xor_b32 v10, v10, v2
    v_lshlrev_b32 v10, 4, v10
    v_lshl_add_u32 v20, v3, 11, v10
    v_xor_b32 v21, 0x80, v20
    s_lshl_b32 s39, s51, 10
    s_lshl_b32 s36, s19, 8
    s_add_u32 s39, s39, s36
    s_lshl_b32 s36, s18, 15
    s_add_u32 s39, s39, s36
    s_add_u32 m0, s43, 0
    s_nop 0
    buffer_load_dwordx4 v20, s[32:35], s39 offen  lds
    s_add_u32 m0, s43, 1024
    s_add_u32 s39, s39, 8192
    buffer_load_dwordx4 v20, s[32:35], s39 offen  lds
    s_add_u32 m0, s43, 2048
    s_add_u32 s39, s39, 8192
    buffer_load_dwordx4 v21, s[32:35], s39 offen  lds
    s_add_u32 m0, s43, 3072
    s_add_u32 s39, s39, 8192
    buffer_load_dwordx4 v21, s[32:35], s39 offen  lds
    v_mov_b32 v26, 0
    buffer_load_dword v26, v26, s[28:31], 0 offen offset:0 sc1
    s_sub_u32 s36, 3, s37
    s_and_b32 s36, s36, 7
    s_lshl_b32 s36, s36, 1
    s_add_u32 s36, s36, 2
    s_sub_u32 s36, 3, s36
    s_add_u32 s38, s61, s36
    s_and_b32 s38, s38, 15
    v_lshlrev_b32 v10, 1, v3
    v_xor_b32 v10, v10, v2
    v_lshlrev_b32 v10, 4, v10
    v_lshl_add_u32 v22, v3, 13, v10
    v_xor_b32 v23, 0x80, v22
    v_and_b32 v10, 3, v2
    v_lshrrev_b32 v11, 3, v2
    v_lshl_or_b32 v10, v11, 2, v10
    v_lshlrev_b32 v10, 1, v10
    v_xor_b32 v10, v10, v3
    v_lshlrev_b32 v10, 4, v10
    v_lshl_add_u32 v10, v2, 8, v10
    v_add_u32 v6, s43, v10
    v_xor_b32 v7, 64, v6
    v_xor_b32 v8, 128, v6
    v_xor_b32 v9, 192, v6
    v_bfe_u32 v4, v1, 2, 2
    v_and_b32 v5, 3, v1
    v_lshrrev_b32 v10, 1, v4
    v_and_b32 v11, 1, v3
    v_lshl_or_b32 v10, v11, 1, v10
    v_lshl_add_u32 v11, v3, 3, v4
    s_lshl_b32 s36, s19, 7
    v_add_u32 v11, s36, v11
    v_lshlrev_b32 v11, 7, v11
    v_lshl_add_u32 v11, v5, 3, v11
    v_xor_b32 v12, 0, v10
    v_lshl_add_u32 v12, v12, 5, v11
    v_xor_b32 v13, 1, v10
    v_lshl_add_u32 v13, v13, 5, v11
    v_xor_b32 v14, 2, v10
    v_lshl_add_u32 v14, v14, 5, v11
    v_xor_b32 v15, 3, v10
    v_lshl_add_u32 v15, v15, 5, v11
    v_xor_b32 v24, v3, v2
    v_and_b32 v24, 15, v24
    v_lshlrev_b32 v24, 4, v24
    v_lshl_add_u32 v24, v2, 8, v24
    v_add_u32 v24, s43, v24
    s_lshl_b32 s36, s19, 2
    v_add_u32 v25, s36, v3
    v_xor_b32 v29, v25, v2
    v_lshlrev_b32 v29, 4, v29
    v_lshl_add_u32 v25, v25, 8, v29
    s_lshl_b32 s36, s18, 14
    s_add_u32 s36, s36, 131072
    v_add_u32 v25, s36, v25
    s_lshl_b32 s36, s51, 5
    s_lshl_b32 s53, s3, 2
    s_add_u32 s36, s36, s53
    v_add_u32 v147, s36, v3
    v_lshlrev_b32 v147, 14, v147
    v_lshl_add_u32 v147, v2, 4, v147
    s_lshl_b32 s53, s52, 8
    s_add_u32 s53, s53, 65536
    s_mov_b32 s44, 0x7060500
    s_mov_b32 s45, 0x7060501
    s_mov_b32 s46, 0x7060502
    s_mov_b32 s47, 0x7060503
    s_mov_b32 s48, 0x0c0c0400
    s_mov_b32 s49, 0x04000c0c
    s_mov_b32 s50, 0xffffff00
    s_waitcnt vmcnt(0)
    v_readfirstlane_b32 s41, v26
    s_nop 3
    s_mul_i32 s40, s41, 0x9E3779B1
    s_add_u32 s40, s40, 0x7F4A7C15
    v_mov_b32 v27, s40
    s_barrier
    ds_read_b128 v[96:99], v6
    ds_read_b128 v[100:103], v7
    ds_read_b128 v[104:107], v8
    ds_read_b128 v[108:111], v9
    ds_read_b64_tr_b16 v[32:33], v12 offset:0
    ds_read_b64_tr_b16 v[34:35], v12 offset:512
    ds_read_b64_tr_b16 v[36:37], v13 offset:0
    ds_read_b64_tr_b16 v[38:39], v13 offset:512
    ds_read_b64_tr_b16 v[40:41], v14 offset:0
    ds_read_b64_tr_b16 v[42:43], v14 offset:512
    ds_read_b64_tr_b16 v[44:45], v15 offset:0
    ds_read_b64_tr_b16 v[46:47], v15 offset:512
    ds_read_b64_tr_b16 v[48:49], v12 offset:4096
    ds_read_b64_tr_b16 v[50:51], v12 offset:4608
    ds_read_b64_tr_b16 v[52:53], v13 offset:4096
    ds_read_b64_tr_b16 v[54:55], v13 offset:4608
    ds_read_b64_tr_b16 v[56:57], v14 offset:4096
    ds_read_b64_tr_b16 v[58:59], v14 offset:4608
    ds_read_b64_tr_b16 v[60:61], v15 offset:4096
    ds_read_b64_tr_b16 v[62:63], v15 offset:4608
    s_waitcnt lgkmcnt(8)
    v_mfma_f32_16x16x32_bf16 v[112:115], v[32:35], v[96:99], 0
    v_mfma_f32_16x16x32_bf16 v[116:119], v[36:39], v[96:99], 0
    v_mfma_f32_16x16x32_bf16 v[120:123], v[40:43], v[96:99], 0
    v_mfma_f32_16x16x32_bf16 v[124:127], v[44:47], v[96:99], 0
    ds_read_b64_tr_b16 v[64:65], v12 offset:8192
    ds_read_b64_tr_b16 v[66:67], v12 offset:8704
    ds_read_b64_tr_b16 v[68:69], v13 offset:8192
    ds_read_b64_tr_b16 v[70:71], v13 offset:8704
    ds_read_b64_tr_b16 v[72:73], v14 offset:8192
    ds_read_b64_tr_b16 v[74:75], v14 offset:8704
    ds_read_b64_tr_b16 v[76:77], v15 offset:8192
    ds_read_b64_tr_b16 v[78:79], v15 offset:8704
    s_waitcnt lgkmcnt(8)
    v_mfma_f32_16x16x32_bf16 v[112:115], v[48:51], v[100:103], v[112:115]
    v_mfma_f32_16x16x32_bf16 v[116:119], v[52:55], v[100:103], v[116:119]
    v_mfma_f32_16x16x32_bf16 v[120:123], v[56:59], v[100:103], v[120:123]
    v_mfma_f32_16x16x32_bf16 v[124:127], v[60:63], v[100:103], v[124:127]
    ds_read_b64_tr_b16 v[80:81], v12 offset:12288
    ds_read_b64_tr_b16 v[82:83], v12 offset:12800
    ds_read_b64_tr_b16 v[84:85], v13 offset:12288
    ds_read_b64_tr_b16 v[86:87], v13 offset:12800
    ds_read_b64_tr_b16 v[88:89], v14 offset:12288
    ds_read_b64_tr_b16 v[90:91], v14 offset:12800
    ds_read_b64_tr_b16 v[92:93], v15 offset:12288
    ds_read_b64_tr_b16 v[94:95], v15 offset:12800
    s_waitcnt lgkmcnt(8)
    v_mfma_f32_16x16x32_bf16 v[112:115], v[64:67], v[104:107], v[112:115]
    v_mfma_f32_16x16x32_bf16 v[116:119], v[68:71], v[104:107], v[116:119]
    v_mfma_f32_16x16x32_bf16 v[120:123], v[72:75], v[104:107], v[120:123]
    v_mfma_f32_16x16x32_bf16 v[124:127], v[76:79], v[104:107], v[124:127]
    s_waitcnt lgkmcnt(0)
    v_mfma_f32_16x16x32_bf16 v[112:115], v[80:83], v[108:111], v[112:115]
    v_mfma_f32_16x16x32_bf16 v[116:119], v[84:87], v[108:111], v[116:119]
    v_mfma_f32_16x16x32_bf16 v[120:123], v[88:91], v[108:111], v[120:123]
    v_mfma_f32_16x16x32_bf16 v[124:127], v[92:95], v[108:111], v[124:127]
    s_nop 4
    s_nop 1
    ds_write_b128 v24, v[112:115]
    v_xor_b32 v28, 64, v24
    ds_write_b128 v28, v[116:119]
    v_xor_b32 v28, 128, v24
    ds_write_b128 v28, v[120:123]
    v_xor_b32 v28, 192, v24
    s_nop 0
    ds_write_b128 v28, v[124:127]
    s_waitcnt lgkmcnt(0)
    s_barrier
    ds_read_b128 v[96:99], v25 offset:0
    ds_read_b128 v[100:103], v25 offset:4096
    ds_read_b128 v[104:107], v25 offset:8192
    ds_read_b128 v[108:111], v25 offset:12288
    s_waitcnt lgkmcnt(0)
    v_pk_add_f32 v[96:97], v[96:97], v[100:101]
    v_pk_add_f32 v[104:105], v[104:105], v[108:109]
    v_pk_add_f32 v[98:99], v[98:99], v[102:103]
    v_pk_add_f32 v[106:107], v[106:107], v[110:111]
    v_pk_add_f32 v[96:97], v[96:97], v[104:105]
    v_pk_add_f32 v[98:99], v[98:99], v[106:107]
    v_perm_b32 v96, v96, v27, s44
    v_perm_b32 v97, v97, v27, s45
    v_perm_b32 v98, v98, v27, s46
    v_perm_b32 v99, v99, v27, s47
    buffer_store_dwordx4 v[96:99], v147, s[28:31], s53 offen sc1
    s_barrier
    v_add_u32 v12, 65536, v12
    v_add_u32 v13, 65536, v13
    v_add_u32 v14, 65536, v14
    v_add_u32 v15, 65536, v15
    s_lshl_b32 s51, s37, 10
    s_lshl_b32 s36, s19, 8
    s_add_u32 s51, s51, s36
    s_lshl_b32 s36, s18, 17
    s_add_u32 s51, s51, s36
    s_add_u32 s51, s51, 1114112
    s_lshl_b32 s36, s37, 5
    s_lshl_b32 s39, s3, 2
    s_add_u32 s36, s36, s39
    v_add_u32 v144, s36, v3
    v_lshlrev_b32 v144, 12, v144
    v_lshl_add_u32 v144, v2, 4, v144
    s_lshl_b32 s62, s38, 8
    s_add_u32 s62, s62, 1376256
    s_lshl_b32 s39, s37, 2
    v_add_u32 v145, s39, v3
    v_lshlrev_b32 v146, 11, v145
    v_lshl_add_u32 v146, v2, 3, v146
    v_lshlrev_b32 v145, 12, v145
    v_lshl_add_u32 v145, v2, 4, v145
    s_lshl_b32 s63, s38, 7
    s_mov_b32 s32, s14
    s_and_b32 s33, s15, 0xffff
    s_mov_b32 s34, 65536
    s_mov_b32 s35, 0x00020000
    v_subrev_u32 v24, 98304, v24
    v_subrev_u32 v25, 98304, v25
    s_sub_u32 s61, s43, 131072
    v_subrev_u32 v148, 131072, v6
    v_subrev_u32 v149, 131072, v7
    v_subrev_u32 v150, 131072, v8
    v_subrev_u32 v151, 131072, v9
    s_mov_b32 s52, 200000
    s_barrier
    ds_read_b64_tr_b16 v[32:33], v12 offset:0
    ds_read_b64_tr_b16 v[34:35], v12 offset:512
    ds_read_b64_tr_b16 v[36:37], v13 offset:0
    ds_read_b64_tr_b16 v[38:39], v13 offset:512
    ds_read_b64_tr_b16 v[40:41], v14 offset:0
    ds_read_b64_tr_b16 v[42:43], v14 offset:512
    ds_read_b64_tr_b16 v[44:45], v15 offset:0
    ds_read_b64_tr_b16 v[46:47], v15 offset:512
    ds_read_b64_tr_b16 v[48:49], v12 offset:4096
    ds_read_b64_tr_b16 v[50:51], v12 offset:4608
    ds_read_b64_tr_b16 v[52:53], v13 offset:4096
    ds_read_b64_tr_b16 v[54:55], v13 offset:4608
    ds_read_b64_tr_b16 v[56:57], v14 offset:4096
    ds_read_b64_tr_b16 v[58:59], v14 offset:4608
    ds_read_b64_tr_b16 v[60:61], v15 offset:4096
    ds_read_b64_tr_b16 v[62:63], v15 offset:4608
    s_waitcnt lgkmcnt(0)
    ds_read_b64_tr_b16 v[64:65], v12 offset:8192
    ds_read_b64_tr_b16 v[66:67], v12 offset:8704
    ds_read_b64_tr_b16 v[68:69], v13 offset:8192
    ds_read_b64_tr_b16 v[70:71], v13 offset:8704
    ds_read_b64_tr_b16 v[72:73], v14 offset:8192
    ds_read_b64_tr_b16 v[74:75], v14 offset:8704
    ds_read_b64_tr_b16 v[76:77], v15 offset:8192
    ds_read_b64_tr_b16 v[78:79], v15 offset:8704
    ds_read_b64_tr_b16 v[80:81], v12 offset:12288
    ds_read_b64_tr_b16 v[82:83], v12 offset:12800
    ds_read_b64_tr_b16 v[84:85], v13 offset:12288
    ds_read_b64_tr_b16 v[86:87], v13 offset:12800
    ds_read_b64_tr_b16 v[88:89], v14 offset:12288
    ds_read_b64_tr_b16 v[90:91], v14 offset:12800
    ds_read_b64_tr_b16 v[92:93], v15 offset:12288
    ds_read_b64_tr_b16 v[94:95], v15 offset:12800
    s_waitcnt lgkmcnt(0)
    s_mov_b32 s39, s51
    s_add_u32 m0, s43, 0
    s_nop 0
    buffer_load_dwordx4 v22, s[28:31], s39 offen sc1 lds
    s_add_u32 m0, s43, 1024
    s_add_u32 s39, s39, 32768
    buffer_load_dwordx4 v22, s[28:31], s39 offen sc1 lds
    s_add_u32 m0, s43, 2048
    s_add_u32 s39, s39, 32768
    buffer_load_dwordx4 v23, s[28:31], s39 offen sc1 lds
    s_add_u32 m0, s43, 3072
    s_add_u32 s39, s39, 32768
    buffer_load_dwordx4 v23, s[28:31], s39 offen sc1 lds
    s_branch L_w_o_wait
L_w_o_loop:
    s_mov_b32 s39, s51
    s_add_u32 m0, s43, 0
    s_nop 0
    buffer_load_dwordx4 v22, s[28:31], s39 offen sc1 lds
    s_add_u32 m0, s43, 1024
    s_add_u32 s39, s39, 32768
    buffer_load_dwordx4 v22, s[28:31], s39 offen sc1 lds
    s_add_u32 m0, s43, 2048
    s_add_u32 s39, s39, 32768
    buffer_load_dwordx4 v23, s[28:31], s39 offen sc1 lds
    s_add_u32 m0, s43, 3072
    s_add_u32 s39, s39, 32768
    buffer_load_dwordx4 v23, s[28:31], s39 offen sc1 lds
L_w_o_wait:
    s_sub_u32 s52, s52, 1
    s_waitcnt vmcnt(0)
    ds_read_b128 v[96:99], v6
    ds_read_b128 v[100:103], v7
    ds_read_b128 v[104:107], v8
    ds_read_b128 v[108:111], v9
    s_cmp_eq_u32 s52, 0
    s_waitcnt lgkmcnt(0)
    s_cbranch_scc1 L_w_o_done
    v_max3_u32 v28, v96, v97, v98
    v_max3_u32 v28, v28, v99, v100
    v_max3_u32 v28, v28, v101, v102
    v_max3_u32 v28, v28, v103, v104
    v_max3_u32 v28, v28, v105, v106
    v_max3_u32 v28, v28, v107, v108
    v_max3_u32 v28, v28, v109, v110
    v_max_u32 v28, v28, v111
    v_cmp_eq_u32 vcc, -1, v28
    s_cbranch_vccnz L_w_o_loop
L_w_o_done:
    v_mfma_f32_16x16x32_bf16 v[112:115], v[32:35], v[96:99], 0
    v_mfma_f32_16x16x32_bf16 v[116:119], v[36:39], v[96:99], 0
    v_mfma_f32_16x16x32_bf16 v[120:123], v[40:43], v[96:99], 0
    v_mfma_f32_16x16x32_bf16 v[124:127], v[44:47], v[96:99], 0
    v_mfma_f32_16x16x32_bf16 v[112:115], v[48:51], v[100:103], v[112:115]
    v_mfma_f32_16x16x32_bf16 v[116:119], v[52:55], v[100:103], v[116:119]
    v_mfma_f32_16x16x32_bf16 v[120:123], v[56:59], v[100:103], v[120:123]
    v_mfma_f32_16x16x32_bf16 v[124:127], v[60:63], v[100:103], v[124:127]
    v_mfma_f32_16x16x32_bf16 v[112:115], v[64:67], v[104:107], v[112:115]
    v_mfma_f32_16x16x32_bf16 v[116:119], v[68:71], v[104:107], v[116:119]
    v_mfma_f32_16x16x32_bf16 v[120:123], v[72:75], v[104:107], v[120:123]
    v_mfma_f32_16x16x32_bf16 v[124:127], v[76:79], v[104:107], v[124:127]
    v_mfma_f32_16x16x32_bf16 v[112:115], v[80:83], v[108:111], v[112:115]
    v_mfma_f32_16x16x32_bf16 v[116:119], v[84:87], v[108:111], v[116:119]
    v_mfma_f32_16x16x32_bf16 v[120:123], v[88:91], v[108:111], v[120:123]
    v_mfma_f32_16x16x32_bf16 v[124:127], v[92:95], v[108:111], v[124:127]
    s_nop 4
    s_nop 1
    ds_write_b128 v24, v[112:115]
    v_xor_b32 v28, 64, v24
    ds_write_b128 v28, v[116:119]
    v_xor_b32 v28, 128, v24
    ds_write_b128 v28, v[120:123]
    v_xor_b32 v28, 192, v24
    s_nop 0
    ds_write_b128 v28, v[124:127]
    s_waitcnt lgkmcnt(0)
    s_barrier
    ds_read_b128 v[96:99], v25 offset:0
    ds_read_b128 v[100:103], v25 offset:4096
    ds_read_b128 v[104:107], v25 offset:8192
    ds_read_b128 v[108:111], v25 offset:12288
    s_waitcnt lgkmcnt(0)
    v_pk_add_f32 v[96:97], v[96:97], v[100:101]
    v_pk_add_f32 v[104:105], v[104:105], v[108:109]
    v_pk_add_f32 v[98:99], v[98:99], v[102:103]
    v_pk_add_f32 v[106:107], v[106:107], v[110:111]
    v_pk_add_f32 v[96:97], v[96:97], v[104:105]
    v_pk_add_f32 v[98:99], v[98:99], v[106:107]
    v_perm_b32 v96, v96, v27, s44
    v_perm_b32 v97, v97, v27, s45
    v_perm_b32 v98, v98, v27, s46
    v_perm_b32 v99, v99, v27, s47
    buffer_store_dwordx4 v[96:99], v144, s[28:31], s62 offen sc1
    s_cmp_lg_u32 s3, 0
    s_cbranch_scc1 L_w_fin
    s_mov_b32 s52, 200000
    s_mov_b32 s39, s62
    buffer_load_dwordx4 v[32:35], v145, s[28:31], s39 offen sc1
    s_add_u32 s39, s39, 131072
    buffer_load_dwordx4 v[36:39], v145, s[28:31], s39 offen sc1
    s_add_u32 s39, s39, 131072
    buffer_load_dwordx4 v[40:43], v145, s[28:31], s39 offen sc1
    s_add_u32 s39, s39, 131072
    buffer_load_dwordx4 v[44:47], v145, s[28:31], s39 offen sc1
    s_add_u32 s39, s39, 131072
    buffer_load_dwordx4 v[48:51], v145, s[28:31], s39 offen sc1
    s_add_u32 s39, s39, 131072
    buffer_load_dwordx4 v[52:55], v145, s[28:31], s39 offen sc1
    s_add_u32 s39, s39, 131072
    buffer_load_dwordx4 v[56:59], v145, s[28:31], s39 offen sc1
    s_add_u32 s39, s39, 131072
    buffer_load_dwordx4 v[60:63], v145, s[28:31], s39 offen sc1
L_w_f_loop:
    s_mov_b32 s39, s62
    buffer_load_dwordx4 v[64:67], v145, s[28:31], s39 offen sc1
    s_add_u32 s39, s39, 131072
    buffer_load_dwordx4 v[68:71], v145, s[28:31], s39 offen sc1
    s_add_u32 s39, s39, 131072
    buffer_load_dwordx4 v[72:75], v145, s[28:31], s39 offen sc1
    s_add_u32 s39, s39, 131072
    buffer_load_dwordx4 v[76:79], v145, s[28:31], s39 offen sc1
    s_add_u32 s39, s39, 131072
    buffer_load_dwordx4 v[80:83], v145, s[28:31], s39 offen sc1
    s_add_u32 s39, s39, 131072
    buffer_load_dwordx4 v[84:87], v145, s[28:31], s39 offen sc1
    s_add_u32 s39, s39, 131072
    buffer_load_dwordx4 v[88:91], v145, s[28:31], s39 offen sc1
    s_add_u32 s39, s39, 131072
    buffer_load_dwordx4 v[92:95], v145, s[28:31], s39 offen sc1
    s_sub_u32 s52, s52, 1
    s_cmp_eq_u32 s52, 0
    s_waitcnt vmcnt(8)
    s_cbranch_scc1 L_w_f_doneA
    v_perm_b32 v30, v33, v32, s48
    v_perm_b32 v31, v35, v34, s49
    v_or_b32 v30, v30, v31
    v_xor_b32 v26, s40, v30
    v_perm_b32 v30, v37, v36, s48
    v_perm_b32 v31, v39, v38, s49
    v_or_b32 v30, v30, v31
    v_xor_b32 v30, s40, v30
    v_or_b32 v26, v26, v30
    v_perm_b32 v30, v41, v40, s48
    v_perm_b32 v31, v43, v42, s49
    v_or_b32 v30, v30, v31
    v_xor_b32 v30, s40, v30
    v_or_b32 v26, v26, v30
    v_perm_b32 v30, v45, v44, s48
    v_perm_b32 v31, v47, v46, s49
    v_or_b32 v30, v30, v31
    v_xor_b32 v30, s40, v30
    v_or_b32 v26, v26, v30
    v_perm_b32 v30, v49, v48, s48
    v_perm_b32 v31, v51, v50, s49
    v_or_b32 v30, v30, v31
    v_xor_b32 v30, s40, v30
    v_or_b32 v26, v26, v30
    v_perm_b32 v30, v53, v52, s48
    v_perm_b32 v31, v55, v54, s49
    v_or_b32 v30, v30, v31
    v_xor_b32 v30, s40, v30
    v_or_b32 v26, v26, v30
    v_perm_b32 v30, v57, v56, s48
    v_perm_b32 v31, v59, v58, s49
    v_or_b32 v30, v30, v31
    v_xor_b32 v30, s40, v30
    v_or_b32 v26, v26, v30
    v_perm_b32 v30, v61, v60, s48
    v_perm_b32 v31, v63, v62, s49
    v_or_b32 v30, v30, v31
    v_xor_b32 v30, s40, v30
    v_or_b32 v26, v26, v30
    v_cmp_ne_u32 vcc, 0, v26
    s_cbranch_vccz L_w_f_doneA
    s_mov_b32 s39, s62
    buffer_load_dwordx4 v[32:35], v145, s[28:31], s39 offen sc1
    s_add_u32 s39, s39, 131072
    buffer_load_dwordx4 v[36:39], v145, s[28:31], s39 offen sc1
    s_add_u32 s39, s39, 131072
    buffer_load_dwordx4 v[40:43], v145, s[28:31], s39 offen sc1
    s_add_u32 s39, s39, 131072
    buffer_load_dwordx4 v[44:47], v145, s[28:31], s39 offen sc1
    s_add_u32 s39, s39, 131072
    buffer_load_dwordx4 v[48:51], v145, s[28:31], s39 offen sc1
    s_add_u32 s39, s39, 131072
    buffer_load_dwordx4 v[52:55], v145, s[28:31], s39 offen sc1
    s_add_u32 s39, s39, 131072
    buffer_load_dwordx4 v[56:59], v145, s[28:31], s39 offen sc1
    s_add_u32 s39, s39, 131072
    buffer_load_dwordx4 v[60:63], v145, s[28:31], s39 offen sc1
    s_waitcnt vmcnt(8)
    v_perm_b32 v30, v65, v64, s48
    v_perm_b32 v31, v67, v66, s49
    v_or_b32 v30, v30, v31
    v_xor_b32 v26, s40, v30
    v_perm_b32 v30, v69, v68, s48
    v_perm_b32 v31, v71, v70, s49
    v_or_b32 v30, v30, v31
    v_xor_b32 v30, s40, v30
    v_or_b32 v26, v26, v30
    v_perm_b32 v30, v73, v72, s48
    v_perm_b32 v31, v75, v74, s49
    v_or_b32 v30, v30, v31
    v_xor_b32 v30, s40, v30
    v_or_b32 v26, v26, v30
    v_perm_b32 v30, v77, v76, s48
    v_perm_b32 v31, v79, v78, s49
    v_or_b32 v30, v30, v31
    v_xor_b32 v30, s40, v30
    v_or_b32 v26, v26, v30
    v_perm_b32 v30, v81, v80, s48
    v_perm_b32 v31, v83, v82, s49
    v_or_b32 v30, v30, v31
    v_xor_b32 v30, s40, v30
    v_or_b32 v26, v26, v30
    v_perm_b32 v30, v85, v84, s48
    v_perm_b32 v31, v87, v86, s49
    v_or_b32 v30, v30, v31
    v_xor_b32 v30, s40, v30
    v_or_b32 v26, v26, v30
    v_perm_b32 v30, v89, v88, s48
    v_perm_b32 v31, v91, v90, s49
    v_or_b32 v30, v30, v31
    v_xor_b32 v30, s40, v30
    v_or_b32 v26, v26, v30
    v_perm_b32 v30, v93, v92, s48
    v_perm_b32 v31, v95, v94, s49
    v_or_b32 v30, v30, v31
    v_xor_b32 v30, s40, v30
    v_or_b32 v26, v26, v30
    v_cmp_ne_u32 vcc, 0, v26
    s_cbranch_vccz L_w_f_doneB
    s_branch L_w_f_loop
L_w_f_doneB:
    v_and_b32 v64, s50, v64
    v_and_b32 v65, s50, v65
    v_and_b32 v66, s50, v66
    v_and_b32 v67, s50, v67
    v_and_b32 v68, s50, v68
    v_and_b32 v69, s50, v69
    v_and_b32 v70, s50, v70
    v_and_b32 v71, s50, v71
    v_and_b32 v72, s50, v72
    v_and_b32 v73, s50, v73
    v_and_b32 v74, s50, v74
    v_and_b32 v75, s50, v75
    v_and_b32 v76, s50, v76
    v_and_b32 v77, s50, v77
    v_and_b32 v78, s50, v78
    v_and_b32 v79, s50, v79
    v_and_b32 v80, s50, v80
    v_and_b32 v81, s50, v81
    v_and_b32 v82, s50, v82
    v_and_b32 v83, s50, v83
    v_and_b32 v84, s50, v84
    v_and_b32 v85, s50, v85
    v_and_b32 v86, s50, v86
    v_and_b32 v87, s50, v87
    v_and_b32 v88, s50, v88
    v_and_b32 v89, s50, v89
    v_and_b32 v90, s50, v90
    v_and_b32 v91, s50, v91
    v_and_b32 v92, s50, v92
    v_and_b32 v93, s50, v93
    v_and_b32 v94, s50, v94
    v_and_b32 v95, s50, v95
    v_pk_add_f32 v[64:65], v[64:65], v[68:69]
    v_pk_add_f32 v[72:73], v[72:73], v[76:77]
    v_pk_add_f32 v[80:81], v[80:81], v[84:85]
    v_pk_add_f32 v[88:89], v[88:89], v[92:93]
    v_pk_add_f32 v[66:67], v[66:67], v[70:71]
    v_pk_add_f32 v[74:75], v[74:75], v[78:79]
    v_pk_add_f32 v[82:83], v[82:83], v[86:87]
    v_pk_add_f32 v[90:91], v[90:91], v[94:95]
    v_pk_add_f32 v[64:65], v[64:65], v[72:73]
    v_pk_add_f32 v[80:81], v[80:81], v[88:89]
    v_pk_add_f32 v[66:67], v[66:67], v[74:75]
    v_pk_add_f32 v[82:83], v[82:83], v[90:91]
    v_pk_add_f32 v[64:65], v[64:65], v[80:81]
    v_pk_add_f32 v[66:67], v[66:67], v[82:83]
    v_cvt_pk_bf16_f32 v64, v64, v65
    v_cvt_pk_bf16_f32 v65, v66, v67
    buffer_store_dwordx2 v[64:65], v146, s[32:35], s63 offen
    s_branch L_w_f_stored
L_w_f_doneA:
    v_and_b32 v32, s50, v32
    v_and_b32 v33, s50, v33
    v_and_b32 v34, s50, v34
    v_and_b32 v35, s50, v35
    v_and_b32 v36, s50, v36
    v_and_b32 v37, s50, v37
    v_and_b32 v38, s50, v38
    v_and_b32 v39, s50, v39
    v_and_b32 v40, s50, v40
    v_and_b32 v41, s50, v41
    v_and_b32 v42, s50, v42
    v_and_b32 v43, s50, v43
    v_and_b32 v44, s50, v44
    v_and_b32 v45, s50, v45
    v_and_b32 v46, s50, v46
    v_and_b32 v47, s50, v47
    v_and_b32 v48, s50, v48
    v_and_b32 v49, s50, v49
    v_and_b32 v50, s50, v50
    v_and_b32 v51, s50, v51
    v_and_b32 v52, s50, v52
    v_and_b32 v53, s50, v53
    v_and_b32 v54, s50, v54
    v_and_b32 v55, s50, v55
    v_and_b32 v56, s50, v56
    v_and_b32 v57, s50, v57
    v_and_b32 v58, s50, v58
    v_and_b32 v59, s50, v59
    v_and_b32 v60, s50, v60
    v_and_b32 v61, s50, v61
    v_and_b32 v62, s50, v62
    v_and_b32 v63, s50, v63
    v_pk_add_f32 v[32:33], v[32:33], v[36:37]
    v_pk_add_f32 v[40:41], v[40:41], v[44:45]
    v_pk_add_f32 v[48:49], v[48:49], v[52:53]
    v_pk_add_f32 v[56:57], v[56:57], v[60:61]
    v_pk_add_f32 v[34:35], v[34:35], v[38:39]
    v_pk_add_f32 v[42:43], v[42:43], v[46:47]
    v_pk_add_f32 v[50:51], v[50:51], v[54:55]
    v_pk_add_f32 v[58:59], v[58:59], v[62:63]
    v_pk_add_f32 v[32:33], v[32:33], v[40:41]
    v_pk_add_f32 v[48:49], v[48:49], v[56:57]
    v_pk_add_f32 v[34:35], v[34:35], v[42:43]
    v_pk_add_f32 v[50:51], v[50:51], v[58:59]
    v_pk_add_f32 v[32:33], v[32:33], v[48:49]
    v_pk_add_f32 v[34:35], v[34:35], v[50:51]
    v_cvt_pk_bf16_f32 v32, v32, v33
    v_cvt_pk_bf16_f32 v33, v34, v35
    buffer_store_dwordx2 v[32:33], v146, s[32:35], s63 offen
L_w_f_stored:
    s_cmp_lg_u32 s2, 0
    s_cbranch_scc1 L_w_fin
    s_add_u32 s41, s41, 1
    v_mov_b32 v28, s41
    v_mov_b32 v29, 0
    s_mov_b64 exec, 1
    buffer_store_dword v28, v29, s[28:31], 0 offen offset:0
    s_mov_b64 exec, -1
L_w_fin:
    s_endpgm
L_help:
    s_sub_u32 s36, 3, s37
    s_and_b32 s36, s36, 7
    s_lshl_b32 s36, s36, 1
    s_add_u32 s36, s36, 2
    s_sub_u32 s36, 3, s36
    s_add_u32 s38, s61, s36
    s_and_b32 s38, s38, 15
    v_lshl_add_u32 v18, v4, 11, v6
    v_xor_b32 v19, 64, v18
    s_waitcnt lgkmcnt(0)
    s_mov_b32 s24, s12
    s_and_b32 s25, s13, 0xffff
    s_mov_b32 s26, 8388608
    s_mov_b32 s27, 0x00020000
    s_mov_b32 s20, s8
    s_and_b32 s21, s9, 0xffff
    s_mov_b32 s22, 67108864
    s_mov_b32 s23, 0x00020000
    s_mov_b32 s28, s16
    s_and_b32 s29, s17, 0xffff
    s_mov_b32 s30, 268435456
    s_mov_b32 s31, 0x00020000
    v_mov_b32 v12, 0
    buffer_load_dword v12, v12, s[28:31], 0 offen offset:0 sc1
    v_and_b32 v28, 31, v1
    v_lshlrev_b32 v28, 4, v28
    s_lshr_b32 s53, s37, 1
    s_lshl_b32 s53, s53, 9
    s_add_u32 s53, s53, 4096
    s_waitcnt vmcnt(0)
    v_readfirstlane_b32 s41, v12
    s_nop 3
    s_mul_i32 s40, s41, 0x9E3779B1
    s_add_u32 s40, s40, 0x7F4A7C15
    v_lshlrev_b32 v8, 7, v1
    s_and_b32 s58, s63, 7
    s_and_b32 s59, s38, 7
    s_cmp_eq_u32 s58, 3
    s_cbranch_scc1 L_h_slowq
    s_cmp_eq_u32 s59, 3
    s_cbranch_scc1 L_h_slowo
    s_barrier
    s_barrier
    s_barrier
    s_lshl_b32 s39, s2, 19
    s_add_u32 s39, s39, 409600
    buffer_load_dword v20, v8, s[20:23], s39 offen
    s_add_u32 s39, s39, 8192
    buffer_load_dword v21, v8, s[20:23], s39 offen
    s_add_u32 s39, s39, 8192
    buffer_load_dword v22, v8, s[20:23], s39 offen
    s_add_u32 s39, s39, 8192
    buffer_load_dword v23, v8, s[20:23], s39 offen
    s_add_u32 s39, s39, 8192
    buffer_load_dword v24, v8, s[20:23], s39 offen
    s_add_u32 s39, s39, 8192
    buffer_load_dword v25, v8, s[20:23], s39 offen
    s_add_u32 s39, s39, 8192
    buffer_load_dword v26, v8, s[20:23], s39 offen
    s_add_u32 s39, s39, 8192
    buffer_load_dword v27, v8, s[20:23], s39 offen
    s_add_u32 s39, s39, 8192
    buffer_load_dword v20, v8, s[20:23], s39 offen
    s_add_u32 s39, s39, 8192
    buffer_load_dword v21, v8, s[20:23], s39 offen
    s_add_u32 s39, s39, 8192
    buffer_load_dword v22, v8, s[20:23], s39 offen
    s_add_u32 s39, s39, 8192
    buffer_load_dword v23, v8, s[20:23], s39 offen
    s_add_u32 s39, s39, 8192
    buffer_load_dword v24, v8, s[20:23], s39 offen
    s_add_u32 s39, s39, 8192
    buffer_load_dword v25, v8, s[20:23], s39 offen
    s_lshl_b32 s39, s37, 20
    s_lshl_b32 s36, s38, 7
    s_add_u32 s39, s39, s36
    s_mov_b32 s42, 65536
    s_mov_b32 s43, 8
L_wo_1:
    s_add_u32 m0, s42, 0
    s_nop 0
    buffer_load_dwordx4 v18, s[24:27], s39 offen nt lds
    s_add_u32 m0, s42, 1024
    s_add_u32 s39, s39, 16384
    buffer_load_dwordx4 v19, s[24:27], s39 offen nt lds
    s_add_u32 m0, s42, 2048
    s_add_u32 s39, s39, 16384
    buffer_load_dwordx4 v18, s[24:27], s39 offen nt lds
    s_add_u32 m0, s42, 3072
    s_add_u32 s39, s39, 16384
    buffer_load_dwordx4 v19, s[24:27], s39 offen nt lds
    s_add_u32 m0, s42, 4096
    s_add_u32 s39, s39, 16384
    buffer_load_dwordx4 v18, s[24:27], s39 offen nt lds
    s_add_u32 m0, s42, 5120
    s_add_u32 s39, s39, 16384
    buffer_load_dwordx4 v19, s[24:27], s39 offen nt lds
    s_add_u32 m0, s42, 6144
    s_add_u32 s39, s39, 16384
    buffer_load_dwordx4 v18, s[24:27], s39 offen nt lds
    s_add_u32 m0, s42, 7168
    s_add_u32 s39, s39, 16384
    buffer_load_dwordx4 v19, s[24:27], s39 offen nt lds
    s_add_u32 s39, s39, 16384
    s_add_u32 s42, s42, 8192
    s_sub_u32 s43, s43, 1
    s_cmp_lg_u32 s43, 0
    s_cbranch_scc1 L_wo_1
    s_branch L_h_issued
L_h_slowo:
    s_barrier
    s_barrier
    s_barrier
    s_lshl_b32 s39, s2, 19
    s_add_u32 s39, s39, 442368
    buffer_load_dword v24, v8, s[20:23], s39 offen
    s_add_u32 s39, s39, 8192
    buffer_load_dword v25, v8, s[20:23], s39 offen
    s_add_u32 s39, s39, 8192
    buffer_load_dword v26, v8, s[20:23], s39 offen
    s_add_u32 s39, s39, 8192
    buffer_load_dword v27, v8, s[20:23], s39 offen
    s_add_u32 s39, s39, 8192
    buffer_load_dword v20, v8, s[20:23], s39 offen
    s_add_u32 s39, s39, 8192
    buffer_load_dword v21, v8, s[20:23], s39 offen
    s_add_u32 s39, s39, 8192
    buffer_load_dword v22, v8, s[20:23], s39 offen
    s_add_u32 s39, s39, 8192
    buffer_load_dword v23, v8, s[20:23], s39 offen
    s_add_u32 s39, s39, 8192
    buffer_load_dword v24, v8, s[20:23], s39 offen
    s_add_u32 s39, s39, 8192
    buffer_load_dword v25, v8, s[20:23], s39 offen
    s_lshl_b32 s39, s37, 20
    s_lshl_b32 s36, s38, 7
    s_add_u32 s39, s39, s36
    s_mov_b32 s42, 65536
    s_mov_b32 s43, 8
L_wo_2:
    s_add_u32 m0, s42, 0
    s_nop 0
    buffer_load_dwordx4 v18, s[24:27], s39 offen nt lds
    s_add_u32 m0, s42, 1024
    s_add_u32 s39, s39, 16384
    buffer_load_dwordx4 v19, s[24:27], s39 offen nt lds
    s_add_u32 m0, s42, 2048
    s_add_u32 s39, s39, 16384
    buffer_load_dwordx4 v18, s[24:27], s39 offen nt lds
    s_add_u32 m0, s42, 3072
    s_add_u32 s39, s39, 16384
    buffer_load_dwordx4 v19, s[24:27], s39 offen nt lds
    s_add_u32 m0, s42, 4096
    s_add_u32 s39, s39, 16384
    buffer_load_dwordx4 v18, s[24:27], s39 offen nt lds
    s_add_u32 m0, s42, 5120
    s_add_u32 s39, s39, 16384
    buffer_load_dwordx4 v19, s[24:27], s39 offen nt lds
    s_add_u32 m0, s42, 6144
    s_add_u32 s39, s39, 16384
    buffer_load_dwordx4 v18, s[24:27], s39 offen nt lds
    s_add_u32 m0, s42, 7168
    s_add_u32 s39, s39, 16384
    buffer_load_dwordx4 v19, s[24:27], s39 offen nt lds
    s_add_u32 s39, s39, 16384
    s_add_u32 s42, s42, 8192
    s_sub_u32 s43, s43, 1
    s_cmp_lg_u32 s43, 0
    s_cbranch_scc1 L_wo_2
    s_branch L_h_issued
L_h_slowq:
    s_barrier
    s_barrier
    s_barrier
    s_lshl_b32 s39, s2, 19
    s_add_u32 s39, s39, 442368
    buffer_load_dword v24, v8, s[20:23], s39 offen
    s_add_u32 s39, s39, 8192
    buffer_load_dword v25, v8, s[20:23], s39 offen
    s_add_u32 s39, s39, 8192
    buffer_load_dword v26, v8, s[20:23], s39 offen
    s_add_u32 s39, s39, 8192
    buffer_load_dword v27, v8, s[20:23], s39 offen
    s_add_u32 s39, s39, 8192
    buffer_load_dword v20, v8, s[20:23], s39 offen
    s_add_u32 s39, s39, 8192
    buffer_load_dword v21, v8, s[20:23], s39 offen
    s_add_u32 s39, s39, 8192
    buffer_load_dword v22, v8, s[20:23], s39 offen
    s_add_u32 s39, s39, 8192
    buffer_load_dword v23, v8, s[20:23], s39 offen
    s_add_u32 s39, s39, 8192
    buffer_load_dword v24, v8, s[20:23], s39 offen
    s_add_u32 s39, s39, 8192
    buffer_load_dword v25, v8, s[20:23], s39 offen
    s_lshl_b32 s39, s37, 20
    s_lshl_b32 s36, s38, 7
    s_add_u32 s39, s39, s36
    s_mov_b32 s42, 65536
    s_mov_b32 s43, 8
L_wo_3:
    s_add_u32 m0, s42, 0
    s_nop 0
    buffer_load_dwordx4 v18, s[24:27], s39 offen nt lds
    s_add_u32 m0, s42, 1024
    s_add_u32 s39, s39, 16384
    buffer_load_dwordx4 v19, s[24:27], s39 offen nt lds
    s_add_u32 m0, s42, 2048
    s_add_u32 s39, s39, 16384
    buffer_load_dwordx4 v18, s[24:27], s39 offen nt lds
    s_add_u32 m0, s42, 3072
    s_add_u32 s39, s39, 16384
    buffer_load_dwordx4 v19, s[24:27], s39 offen nt lds
    s_add_u32 m0, s42, 4096
    s_add_u32 s39, s39, 16384
    buffer_load_dwordx4 v18, s[24:27], s39 offen nt lds
    s_add_u32 m0, s42, 5120
    s_add_u32 s39, s39, 16384
    buffer_load_dwordx4 v19, s[24:27], s39 offen nt lds
    s_add_u32 m0, s42, 6144
    s_add_u32 s39, s39, 16384
    buffer_load_dwordx4 v18, s[24:27], s39 offen nt lds
    s_add_u32 m0, s42, 7168
    s_add_u32 s39, s39, 16384
    buffer_load_dwordx4 v19, s[24:27], s39 offen nt lds
    s_add_u32 s39, s39, 16384
    s_add_u32 s42, s42, 8192
    s_sub_u32 s43, s43, 1
    s_cmp_lg_u32 s43, 0
    s_cbranch_scc1 L_wo_3
L_h_issued:
    s_mov_b32 s52, 200000
L_go2:
    buffer_load_dword v29, v28, s[28:31], s53 offen sc1
    s_sub_u32 s52, s52, 1
    s_cmp_eq_u32 s52, 0
    s_cbranch_scc1 L_go2_done
    s_waitcnt vmcnt(0)
    v_cmp_eq_u32 vcc, s40, v29
    s_bcnt1_i32_b64 s36, vcc
    s_cmp_lt_u32 s36, 64
    s_cbranch_scc1 L_go2
L_go2_done:
    s_waitcnt vmcnt(0)
    s_barrier
    s_endpgm
L_attn:
    s_sub_u32 s18, s2, 128
    s_lshr_b32 s19, s18, 2
    s_and_b32 s37, s18, 3
    v_lshlrev_b32 v10, 1, v3
    v_xor_b32 v10, v10, v2
    v_lshlrev_b32 v10, 4, v10
    v_lshl_add_u32 v4, v3, 8, v10
    v_xor_b32 v5, 0x80, v4
    s_lshl_b32 s38, s18, 19
    s_add_u32 s38, s38, 393216
    s_mov_b32 s61, 1
    s_and_b32 s58, s18, 7
    s_lshr_b32 s59, s18, 3
    s_sub_u32 s58, 3, s58
    s_and_b32 s58, s58, 7
    s_lshr_b32 s60, s59, 1
    s_cmp_eq_u32 s60, s58
    s_cselect_b32 s61, 3, s61
    s_lshl_b32 s58, s58, 1
    s_add_u32 s58, s58, 2
    s_and_b32 s58, s58, 7
    s_and_b32 s59, s59, 7
    s_cmp_eq_u32 s59, s58
    s_cselect_b32 s61, 3, s61
    s_cmp_eq_u32 s3, 8
    s_cbranch_scc1 L_svc
    s_lshl_b32 s42, s3, 14
    v_and_b32 v10, 3, v2
    v_lshrrev_b32 v11, 3, v2
    v_lshl_or_b32 v10, v11, 2, v10
    v_lshlrev_b32 v10, 1, v10
    v_xor_b32 v10, v10, v3
    v_lshlrev_b32 v10, 4, v10
    v_lshl_add_u32 v10, v2, 8, v10
    v_add_u32 v6, s42, v10
    v_xor_b32 v7, 64, v6
    v_xor_b32 v8, 128, v6
    v_xor_b32 v9, 192, v6
    s_add_u32 s38, s38, s42
    s_waitcnt lgkmcnt(0)
    s_mov_b32 s20, s6
    s_and_b32 s21, s7, 0xffff
    s_mov_b32 s22, 67108864
    s_mov_b32 s23, 0x00020000
    s_mov_b32 s24, s8
    s_and_b32 s25, s9, 0xffff
    s_mov_b32 s26, 67108864
    s_mov_b32 s27, 0x00020000
    s_mov_b32 s28, s16
    s_and_b32 s29, s17, 0xffff
    s_mov_b32 s30, 268435456
    s_mov_b32 s31, 0x00020000
    v_mov_b32 v114, 0
    buffer_load_dword v114, v114, s[28:31], 0 offen offset:0 sc1
    v_mov_b32 v12, 0
    buffer_load_dword v13, v12, s[20:23], s38 offen
    s_waitcnt vmcnt(0)
    s_setprio 2
    s_add_u32 m0, s42, 0
    s_add_u32 s39, s38, 0
    buffer_load_dwordx4 v4, s[20:23], s39 offen offset:0 nt lds
    buffer_load_dwordx4 v4, s[20:23], s39 offen offset:1024 nt lds
    buffer_load_dwordx4 v5, s[20:23], s39 offen offset:2048 nt lds
    buffer_load_dwordx4 v5, s[20:23], s39 offen offset:3072 nt lds
    s_add_u32 m0, s42, 4096
    s_add_u32 s39, s38, 4096
    buffer_load_dwordx4 v4, s[20:23], s39 offen offset:0 nt lds
    buffer_load_dwordx4 v4, s[20:23], s39 offen offset:1024 nt lds
    buffer_load_dwordx4 v5, s[20:23], s39 offen offset:2048 nt lds
    buffer_load_dwordx4 v5, s[20:23], s39 offen offset:3072 nt lds
    s_add_u32 m0, s42, 8192
    s_add_u32 s39, s38, 8192
    buffer_load_dwordx4 v4, s[20:23], s39 offen offset:0 nt lds
    buffer_load_dwordx4 v4, s[20:23], s39 offen offset:1024 nt lds
    buffer_load_dwordx4 v5, s[20:23], s39 offen offset:2048 nt lds
    buffer_load_dwordx4 v5, s[20:23], s39 offen offset:3072 nt lds
    s_add_u32 m0, s42, 12288
    s_add_u32 s39, s38, 12288
    buffer_load_dwordx4 v4, s[20:23], s39 offen offset:0 nt lds
    buffer_load_dwordx4 v4, s[20:23], s39 offen offset:1024 nt lds
    buffer_load_dwordx4 v5, s[20:23], s39 offen offset:2048 nt lds
    buffer_load_dwordx4 v5, s[20:23], s39 offen offset:3072 nt lds
    s_setprio 0
    s_waitcnt vmcnt(0)
    ds_read_b128 v[16:19], v6 offset:0
    ds_read_b128 v[20:23], v7 offset:0
    ds_read_b128 v[24:27], v8 offset:0
    ds_read_b128 v[28:31], v9 offset:0
    ds_read_b128 v[32:35], v6 offset:4096
    ds_read_b128 v[36:39], v7 offset:4096
    ds_read_b128 v[40:43], v8 offset:4096
    ds_read_b128 v[44:47], v9 offset:4096
    s_waitcnt lgkmcnt(0)
    ds_read_b128 v[48:51], v6 offset:8192
    ds_read_b128 v[52:55], v7 offset:8192
    ds_read_b128 v[56:59], v8 offset:8192
    ds_read_b128 v[60:63], v9 offset:8192
    ds_read_b128 v[64:67], v6 offset:12288
    ds_read_b128 v[68:71], v7 offset:12288
    ds_read_b128 v[72:75], v8 offset:12288
    ds_read_b128 v[76:79], v9 offset:12288
    s_waitcnt lgkmcnt(0)
    s_cmp_ge_u32 s3, s61
    s_cbranch_scc1 L_a_nov
    s_add_u32 m0, s42, 0
    s_add_u32 s39, s38, 0
    buffer_load_dwordx4 v4, s[24:27], s39 offen offset:0 nt lds
    buffer_load_dwordx4 v4, s[24:27], s39 offen offset:1024 nt lds
    buffer_load_dwordx4 v5, s[24:27], s39 offen offset:2048 nt lds
    buffer_load_dwordx4 v5, s[24:27], s39 offen offset:3072 nt lds
    s_add_u32 m0, s42, 4096
    s_add_u32 s39, s38, 4096
    buffer_load_dwordx4 v4, s[24:27], s39 offen offset:0 nt lds
    buffer_load_dwordx4 v4, s[24:27], s39 offen offset:1024 nt lds
    buffer_load_dwordx4 v5, s[24:27], s39 offen offset:2048 nt lds
    buffer_load_dwordx4 v5, s[24:27], s39 offen offset:3072 nt lds
    s_add_u32 m0, s42, 8192
    s_add_u32 s39, s38, 8192
    buffer_load_dwordx4 v4, s[24:27], s39 offen offset:0 nt lds
    buffer_load_dwordx4 v4, s[24:27], s39 offen offset:1024 nt lds
    buffer_load_dwordx4 v5, s[24:27], s39 offen offset:2048 nt lds
    buffer_load_dwordx4 v5, s[24:27], s39 offen offset:3072 nt lds
    s_add_u32 m0, s42, 12288
    s_add_u32 s39, s38, 12288
    buffer_load_dwordx4 v4, s[24:27], s39 offen offset:0 nt lds
    buffer_load_dwordx4 v4, s[24:27], s39 offen offset:1024 nt lds
    buffer_load_dwordx4 v5, s[24:27], s39 offen offset:2048 nt lds
    buffer_load_dwordx4 v5, s[24:27], s39 offen offset:3072 nt lds
L_a_nov:
    s_barrier
    v_and_b32 v12, 7, v2
    v_mul_u32_u24 v13, 288, v12
    v_lshl_add_u32 v13, v3, 4, v13
    v_add_u32 v13, 139520, v13
    v_lshlrev_b32 v14, 5, v12
    v_add_u32 v14, 141824, v14
    s_lshl_b32 s36, s3, 2
    v_add_u32 v15, s36, v14
    v_mul_u32_u24 v112, 1056, v12
    v_lshl_add_u32 v112, v3, 3, v112
    v_lshrrev_b32 v113, 3, v2
    v_lshl_add_u32 v112, v113, 6, v112
    v_cmp_lt_u32 s[56:57], 7, v2
    s_lshl_b32 s36, s3, 7
    s_add_u32 s36, s36, 131072
    v_add_u32 v112, s36, v112
    s_mov_b32 s43, 0x3e0293ee
    v_mul_u32_u24 v4, 1056, v12
    v_lshl_add_u32 v4, v3, 4, v4
    v_add_u32 v4, 131072, v4
    v_lshlrev_b32 v5, 5, v12
    v_add_u32 v5, 142336, v5
    v_bfe_u32 v6, v1, 2, 2
    v_and_b32 v7, 3, v1
    v_and_b32 v8, 1, v3
    v_lshl_or_b32 v8, v8, 2, v6
    v_lshlrev_b32 v8, 1, v8
    v_lshrrev_b32 v9, 1, v7
    s_lshl_b32 s36, s3, 2
    v_add_u32 v9, s36, v9
    v_lshl_add_u32 v10, v3, 3, v6
    v_lshlrev_b32 v10, 8, v10
    v_and_b32 v7, 1, v7
    v_lshl_add_u32 v10, v7, 3, v10
    v_xor_b32 v11, v9, v8
    v_lshl_add_u32 v6, v11, 4, v10
    v_add_u32 v9, 2, v9
    v_xor_b32 v11, v9, v8
    v_lshl_add_u32 v7, v11, 4, v10
    v_add_u32 v8, 0x10000, v6
    v_add_u32 v9, 0x10000, v7
    s_lshl_b32 s36, s37, 3
    v_add_u32 v10, s36, v2
    v_lshlrev_b32 v10, 8, v10
    v_and_b32 v11, 1, v3
    v_lshl_add_u32 v10, v11, 5, v10
    v_lshrrev_b32 v11, 1, v3
    v_lshl_add_u32 v152, v11, 4, v10
    s_lshl_b32 s51, s19, 13
    s_lshl_b32 s39, s3, 6
    s_add_u32 s51, s51, s39
    s_add_u32 s51, s51, 1114112
    s_cmp_ge_u32 s3, 4
    s_cbranch_scc1 L_a_b1
    v_readfirstlane_b32 s41, v114
    s_nop 3
    s_mul_i32 s40, s41, 0x9E3779B1
    s_add_u32 s40, s40, 0x7F4A7C15
    s_mov_b32 s44, 0x7060500
    s_mov_b32 s45, 0x7060501
    s_mov_b32 s46, 0x7060502
    s_mov_b32 s47, 0x7060503
    s_mov_b32 s48, 0x0c0c0400
    s_mov_b32 s49, 0x04000c0c
    s_mov_b32 s50, 0xffffff00
    s_lshl_b32 s36, s19, 14
    s_lshl_b32 s39, s37, 12
    s_add_u32 s36, s36, s39
    s_lshl_b32 s39, s3, 10
    s_add_u32 s36, s36, s39
    s_add_u32 s36, s36, 65536
    s_add_u32 s53, s36, 524288
    v_lshlrev_b32 v114, 4, v1
    v_lshrrev_b32 v115, 5, v1
    s_lshl_b32 s39, s3, 1
    v_add_u32 v115, s39, v115
    v_mul_u32_u24 v115, 288, v115
    v_and_b32 v116, 31, v1
    v_lshl_add_u32 v115, v116, 3, v115
    v_add_u32 v115, 139520, v115
    s_mov_b32 s52, 200000
    s_setprio 3
L_q4_loop:
    buffer_load_dwordx4 v[120:123], v114, s[28:31], s36 offen sc1
    buffer_load_dwordx4 v[124:127], v114, s[28:31], s53 offen sc1
    s_sub_u32 s52, s52, 1
    s_cmp_eq_u32 s52, 0
    s_waitcnt vmcnt(0)
    s_cbranch_scc1 L_q4_done
    v_perm_b32 v116, v121, v120, s48
    v_perm_b32 v117, v123, v122, s49
    v_or_b32 v116, v116, v117
    v_xor_b32 v118, s40, v116
    v_perm_b32 v116, v125, v124, s48
    v_perm_b32 v117, v127, v126, s49
    v_or_b32 v116, v116, v117
    v_xor_b32 v116, s40, v116
    v_or_b32 v118, v118, v116
    v_cmp_ne_u32 vcc, 0, v118
    s_cbranch_vccnz L_q4_loop
L_q4_done:
    s_setprio 0
    v_and_b32 v120, s50, v120
    v_and_b32 v121, s50, v121
    v_and_b32 v122, s50, v122
    v_and_b32 v123, s50, v123
    v_and_b32 v124, s50, v124
    v_and_b32 v125, s50, v125
    v_and_b32 v126, s50, v126
    v_and_b32 v127, s50, v127
    v_add_f32 v120, v120, v124
    v_add_f32 v121, v121, v125
    v_add_f32 v122, v122, v126
    v_add_f32 v123, v123, v127
    v_cvt_pk_bf16_f32 v120, v120, v121
    v_cvt_pk_bf16_f32 v121, v122, v123
    ds_write_b64 v115, v[120:121]
    s_waitcnt lgkmcnt(0)
L_a_b1:
    s_barrier
    ds_read_b128 v[80:83], v13 offset:0
    ds_read_b128 v[84:87], v13 offset:64
    ds_read_b128 v[88:91], v13 offset:128
    ds_read_b128 v[92:95], v13 offset:192
    s_waitcnt lgkmcnt(0)
    v_mfma_f32_16x16x32_bf16 v[96:99], v[16:19], v[80:83], 0
    v_mfma_f32_16x16x32_bf16 v[96:99], v[20:23], v[84:87], v[96:99]
    v_mfma_f32_16x16x32_bf16 v[96:99], v[24:27], v[88:91], v[96:99]
    v_mfma_f32_16x16x32_bf16 v[96:99], v[28:31], v[92:95], v[96:99]
    v_mfma_f32_16x16x32_bf16 v[100:103], v[32:35], v[80:83], 0
    v_mfma_f32_16x16x32_bf16 v[100:103], v[36:39], v[84:87], v[100:103]
    v_mfma_f32_16x16x32_bf16 v[100:103], v[40:43], v[88:91], v[100:103]
    v_mfma_f32_16x16x32_bf16 v[100:103], v[44:47], v[92:95], v[100:103]
    v_mfma_f32_16x16x32_bf16 v[104:107], v[48:51], v[80:83], 0
    v_mfma_f32_16x16x32_bf16 v[104:107], v[52:55], v[84:87], v[104:107]
    v_mfma_f32_16x16x32_bf16 v[104:107], v[56:59], v[88:91], v[104:107]
    v_mfma_f32_16x16x32_bf16 v[104:107], v[60:63], v[92:95], v[104:107]
    v_mfma_f32_16x16x32_bf16 v[108:111], v[64:67], v[80:83], 0
    v_mfma_f32_16x16x32_bf16 v[108:111], v[68:71], v[84:87], v[108:111]
    v_mfma_f32_16x16x32_bf16 v[108:111], v[72:75], v[88:91], v[108:111]
    v_mfma_f32_16x16x32_bf16 v[108:111], v[76:79], v[92:95], v[108:111]
    s_nop 7
    s_nop 1
    v_cndmask_b32 v96, v96, v104, s[56:57]
    v_cndmask_b32 v97, v97, v105, s[56:57]
    v_cndmask_b32 v98, v98, v106, s[56:57]
    v_cndmask_b32 v99, v99, v107, s[56:57]
    v_cndmask_b32 v100, v100, v108, s[56:57]
    v_cndmask_b32 v101, v101, v109, s[56:57]
    v_cndmask_b32 v102, v102, v110, s[56:57]
    v_cndmask_b32 v103, v103, v111, s[56:57]
    v_max3_f32 v10, v96, v97, v98
    v_max3_f32 v10, v10, v99, v100
    v_max3_f32 v10, v10, v101, v102
    v_max_f32 v10, v10, v103
    s_nop 1
    v_max_f32_dpp v10, v10, v10 row_ror:8 row_mask:0xf bank_mask:0xf
    v_mov_b32 v11, v10
    s_nop 1
    v_permlane16_swap_b32 v10, v11
    s_nop 1
    v_max_f32 v10, v10, v11
    v_mov_b32 v11, v10
    s_nop 1
    v_permlane32_swap_b32 v10, v11
    s_nop 1
    v_max_f32 v10, v10, v11
    ds_write_b32 v15, v10
    s_waitcnt lgkmcnt(0)
    s_barrier
    ds_read_b128 v[80:83], v14
    ds_read_b128 v[84:87], v14 offset:16
    s_waitcnt lgkmcnt(0)
    v_max3_f32 v10, v80, v81, v82
    v_max3_f32 v10, v10, v83, v84
    v_max3_f32 v10, v10, v85, v86
    v_max_f32 v10, v10, v87
    v_mul_f32 v10, s43, v10
    v_fma_f32 v96, v96, s43, -v10
    v_fma_f32 v97, v97, s43, -v10
    v_fma_f32 v98, v98, s43, -v10
    v_fma_f32 v99, v99, s43, -v10
    v_fma_f32 v100, v100, s43, -v10
    v_fma_f32 v101, v101, s43, -v10
    v_fma_f32 v102, v102, s43, -v10
    v_fma_f32 v103, v103, s43, -v10
    v_exp_f32 v96, v96
    v_exp_f32 v97, v97
    v_exp_f32 v98, v98
    v_exp_f32 v99, v99
    v_exp_f32 v100, v100
    v_exp_f32 v101, v101
    v_exp_f32 v102, v102
    v_exp_f32 v103, v103
    s_nop 0
    v_cvt_pk_bf16_f32 v80, v96, v97
    v_cvt_pk_bf16_f32 v81, v98, v99
    v_cvt_pk_bf16_f32 v82, v100, v101
    v_cvt_pk_bf16_f32 v83, v102, v103
    ds_write_b64 v112, v[80:81] offset:0
    ds_write_b64 v112, v[82:83] offset:32
    v_add_f32 v11, v96, v97
    v_add_f32 v11, v11, v98
    v_add_f32 v11, v11, v99
    v_add_f32 v11, v11, v100
    v_add_f32 v11, v11, v101
    v_add_f32 v11, v11, v102
    v_add_f32 v11, v11, v103
    s_nop 1
    v_add_f32_dpp v11, v11, v11 row_ror:8 row_mask:0xf bank_mask:0xf
    v_mov_b32 v10, v11
    s_nop 1
    v_permlane16_swap_b32 v11, v10
    s_nop 1
    v_add_f32 v11, v11, v10
    v_mov_b32 v10, v11
    s_nop 1
    v_permlane32_swap_b32 v11, v10
    s_nop 1
    v_add_f32 v11, v11, v10
    ds_write_b32 v15, v11 offset:512
    s_cmp_ge_u32 s3, 4
    s_cbranch_scc1 L_a_late
    s_waitcnt vmcnt(0) lgkmcnt(0)
    s_barrier
    ds_read_b128 v[16:19], v4 offset:0
    ds_read_b128 v[20:23], v4 offset:64
    ds_read_b128 v[24:27], v4 offset:128
    ds_read_b128 v[28:31], v4 offset:192
    ds_read_b128 v[32:35], v4 offset:256
    ds_read_b128 v[36:39], v4 offset:320
    ds_read_b128 v[40:43], v4 offset:384
    ds_read_b128 v[44:47], v4 offset:448
    ds_read_b64_tr_b16 v[104:105], v6 offset:0
    ds_read_b64_tr_b16 v[106:107], v6 offset:1024
    ds_read_b64_tr_b16 v[108:109], v7 offset:0
    ds_read_b64_tr_b16 v[110:111], v7 offset:1024
    ds_read_b64_tr_b16 v[112:113], v6 offset:8192
    ds_read_b64_tr_b16 v[114:115], v6 offset:9216
    ds_read_b64_tr_b16 v[116:117], v7 offset:8192
    ds_read_b64_tr_b16 v[118:119], v7 offset:9216
    ds_read_b64_tr_b16 v[120:121], v6 offset:16384
    ds_read_b64_tr_b16 v[122:123], v6 offset:17408
    ds_read_b64_tr_b16 v[124:125], v7 offset:16384
    ds_read_b64_tr_b16 v[126:127], v7 offset:17408
    ds_read_b64_tr_b16 v[128:129], v6 offset:24576
    ds_read_b64_tr_b16 v[130:131], v6 offset:25600
    ds_read_b64_tr_b16 v[132:133], v7 offset:24576
    ds_read_b64_tr_b16 v[134:135], v7 offset:25600
    s_waitcnt lgkmcnt(12)
    v_mfma_f32_16x16x32_bf16 v[96:99], v[104:107], v[16:19], 0
    v_mfma_f32_16x16x32_bf16 v[100:103], v[108:111], v[16:19], 0
    ds_read_b64_tr_b16 v[136:137], v6 offset:32768
    ds_read_b64_tr_b16 v[138:139], v6 offset:33792
    ds_read_b64_tr_b16 v[140:141], v7 offset:32768
    ds_read_b64_tr_b16 v[142:143], v7 offset:33792
    s_waitcnt lgkmcnt(12)
    v_mfma_f32_16x16x32_bf16 v[96:99], v[112:115], v[20:23], v[96:99]
    v_mfma_f32_16x16x32_bf16 v[100:103], v[116:119], v[20:23], v[100:103]
    ds_read_b64_tr_b16 v[144:145], v6 offset:40960
    ds_read_b64_tr_b16 v[146:147], v6 offset:41984
    ds_read_b64_tr_b16 v[148:149], v7 offset:40960
    ds_read_b64_tr_b16 v[150:151], v7 offset:41984
    s_waitcnt lgkmcnt(12)
    v_mfma_f32_16x16x32_bf16 v[96:99], v[120:123], v[24:27], v[96:99]
    v_mfma_f32_16x16x32_bf16 v[100:103], v[124:127], v[24:27], v[100:103]
    ds_read_b64_tr_b16 v[104:105], v6 offset:49152
    ds_read_b64_tr_b16 v[106:107], v6 offset:50176
    ds_read_b64_tr_b16 v[108:109], v7 offset:49152
    ds_read_b64_tr_b16 v[110:111], v7 offset:50176
    s_waitcnt lgkmcnt(12)
    v_mfma_f32_16x16x32_bf16 v[96:99], v[128:131], v[28:31], v[96:99]
    v_mfma_f32_16x16x32_bf16 v[100:103], v[132:135], v[28:31], v[100:103]
    ds_read_b64_tr_b16 v[112:113], v6 offset:57344
    ds_read_b64_tr_b16 v[114:115], v6 offset:58368
    ds_read_b64_tr_b16 v[116:117], v7 offset:57344
    ds_read_b64_tr_b16 v[118:119], v7 offset:58368
    s_waitcnt lgkmcnt(12)
    v_mfma_f32_16x16x32_bf16 v[96:99], v[136:139], v[32:35], v[96:99]
    v_mfma_f32_16x16x32_bf16 v[100:103], v[140:143], v[32:35], v[100:103]
    s_waitcnt lgkmcnt(8)
    v_mfma_f32_16x16x32_bf16 v[96:99], v[144:147], v[36:39], v[96:99]
    v_mfma_f32_16x16x32_bf16 v[100:103], v[148:151], v[36:39], v[100:103]
    s_waitcnt lgkmcnt(4)
    v_mfma_f32_16x16x32_bf16 v[96:99], v[104:107], v[40:43], v[96:99]
    v_mfma_f32_16x16x32_bf16 v[100:103], v[108:111], v[40:43], v[100:103]
    s_waitcnt lgkmcnt(0)
    v_mfma_f32_16x16x32_bf16 v[96:99], v[112:115], v[44:47], v[96:99]
    v_mfma_f32_16x16x32_bf16 v[100:103], v[116:119], v[44:47], v[100:103]
    ds_read_b128 v[80:83], v5
    ds_read_b128 v[84:87], v5 offset:16
    ds_read_b128 v[48:51], v4 offset:512
    ds_read_b128 v[52:55], v4 offset:576
    ds_read_b128 v[56:59], v4 offset:640
    ds_read_b128 v[60:63], v4 offset:704
    ds_read_b128 v[64:67], v4 offset:768
    ds_read_b128 v[68:71], v4 offset:832
    ds_read_b128 v[72:75], v4 offset:896
    ds_read_b128 v[76:79], v4 offset:960
    s_waitcnt lgkmcnt(8)
    v_add_f32 v80, v80, v81
    v_add_f32 v82, v82, v83
    v_add_f32 v84, v84, v85
    v_add_f32 v86, v86, v87
    v_add_f32 v80, v80, v82
    v_add_f32 v84, v84, v86
    v_add_f32 v80, v80, v84
    v_rcp_f32 v13, v80
    s_waitcnt lgkmcnt(0)
    s_barrier
    ds_read_b64_tr_b16 v[120:121], v8 offset:0
    ds_read_b64_tr_b16 v[122:123], v8 offset:1024
    ds_read_b64_tr_b16 v[124:125], v9 offset:0
    ds_read_b64_tr_b16 v[126:127], v9 offset:1024
    ds_read_b64_tr_b16 v[128:129], v8 offset:16384
    ds_read_b64_tr_b16 v[130:131], v8 offset:17408
    ds_read_b64_tr_b16 v[132:133], v9 offset:16384
    ds_read_b64_tr_b16 v[134:135], v9 offset:17408
    ds_read_b64_tr_b16 v[136:137], v8 offset:32768
    ds_read_b64_tr_b16 v[138:139], v8 offset:33792
    ds_read_b64_tr_b16 v[140:141], v9 offset:32768
    ds_read_b64_tr_b16 v[142:143], v9 offset:33792
    ds_read_b64_tr_b16 v[144:145], v8 offset:49152
    ds_read_b64_tr_b16 v[146:147], v8 offset:50176
    ds_read_b64_tr_b16 v[148:149], v9 offset:49152
    ds_read_b64_tr_b16 v[150:151], v9 offset:50176
    s_waitcnt lgkmcnt(12)
    v_mfma_f32_16x16x32_bf16 v[96:99], v[120:123], v[48:51], v[96:99]
    v_mfma_f32_16x16x32_bf16 v[100:103], v[124:127], v[48:51], v[100:103]
    s_waitcnt lgkmcnt(8)
    v_mfma_f32_16x16x32_bf16 v[96:99], v[128:131], v[56:59], v[96:99]
    v_mfma_f32_16x16x32_bf16 v[100:103], v[132:135], v[56:59], v[100:103]
    s_waitcnt lgkmcnt(4)
    v_mfma_f32_16x16x32_bf16 v[96:99], v[136:139], v[64:67], v[96:99]
    v_mfma_f32_16x16x32_bf16 v[100:103], v[140:143], v[64:67], v[100:103]
    s_waitcnt lgkmcnt(0)
    v_mfma_f32_16x16x32_bf16 v[96:99], v[144:147], v[72:75], v[96:99]
    v_mfma_f32_16x16x32_bf16 v[100:103], v[148:151], v[72:75], v[100:103]
    s_barrier
    ds_read_b64_tr_b16 v[104:105], v8 offset:8192
    ds_read_b64_tr_b16 v[106:107], v8 offset:9216
    ds_read_b64_tr_b16 v[108:109], v9 offset:8192
    ds_read_b64_tr_b16 v[110:111], v9 offset:9216
    ds_read_b64_tr_b16 v[112:113], v8 offset:24576
    ds_read_b64_tr_b16 v[114:115], v8 offset:25600
    ds_read_b64_tr_b16 v[116:117], v9 offset:24576
    ds_read_b64_tr_b16 v[118:119], v9 offset:25600
    ds_read_b64_tr_b16 v[120:121], v8 offset:40960
    ds_read_b64_tr_b16 v[122:123], v8 offset:41984
    ds_read_b64_tr_b16 v[124:125], v9 offset:40960
    ds_read_b64_tr_b16 v[126:127], v9 offset:41984
    ds_read_b64_tr_b16 v[128:129], v8 offset:57344
    ds_read_b64_tr_b16 v[130:131], v8 offset:58368
    ds_read_b64_tr_b16 v[132:133], v9 offset:57344
    ds_read_b64_tr_b16 v[134:135], v9 offset:58368
    s_waitcnt lgkmcnt(12)
    v_mfma_f32_16x16x32_bf16 v[96:99], v[104:107], v[52:55], v[96:99]
    v_mfma_f32_16x16x32_bf16 v[100:103], v[108:111], v[52:55], v[100:103]
    s_waitcnt lgkmcnt(8)
    v_mfma_f32_16x16x32_bf16 v[96:99], v[112:115], v[60:63], v[96:99]
    v_mfma_f32_16x16x32_bf16 v[100:103], v[116:119], v[60:63], v[100:103]
    s_waitcnt lgkmcnt(4)
    v_mfma_f32_16x16x32_bf16 v[96:99], v[120:123], v[68:71], v[96:99]
    v_mfma_f32_16x16x32_bf16 v[100:103], v[124:127], v[68:71], v[100:103]
    s_waitcnt lgkmcnt(0)
    v_mfma_f32_16x16x32_bf16 v[96:99], v[128:131], v[76:79], v[96:99]
    v_mfma_f32_16x16x32_bf16 v[100:103], v[132:135], v[76:79], v[100:103]
    s_nop 7
    s_nop 0
    v_mul_f32 v96, v96, v13
    v_mul_f32 v97, v97, v13
    v_mul_f32 v98, v98, v13
    v_mul_f32 v99, v99, v13
    v_mul_f32 v100, v100, v13
    v_mul_f32 v101, v101, v13
    v_mul_f32 v102, v102, v13
    v_mul_f32 v103, v103, v13
    v_cvt_pk_bf16_f32 v16, v96, v97
    v_cvt_pk_bf16_f32 v17, v98, v99
    v_cvt_pk_bf16_f32 v18, v100, v101
    v_cvt_pk_bf16_f32 v19, v102, v103
    v_min_u32 v16, -2, v16
    v_min_u32 v17, -2, v17
    v_min_u32 v18, -2, v18
    v_min_u32 v19, -2, v19
    v_cmp_gt_u32 vcc, 8, v2
    s_nop 0
    v_permlane16_swap_b32 v16, v18
    v_permlane16_swap_b32 v17, v19
    s_and_saveexec_b64 s[58:59], vcc
    buffer_store_dwordx4 v[16:19], v152, s[28:31], s51 offen sc1
    s_mov_b64 exec, s[58:59]
    s_endpgm
L_a_late:
    s_waitcnt lgkmcnt(0)
    s_barrier
    s_endpgm
L_svc:
    s_setprio 3
    s_waitcnt lgkmcnt(0)
    s_mov_b32 s28, s16
    s_and_b32 s29, s17, 0xffff
    s_mov_b32 s30, 268435456
    s_mov_b32 s31, 0x00020000
    s_mov_b32 s24, s8
    s_and_b32 s25, s9, 0xffff
    s_mov_b32 s26, 67108864
    s_mov_b32 s27, 0x00020000
    s_lshl_b32 s36, s19, 13
    s_lshl_b32 s39, s37, 11
    s_add_u32 s36, s36, s39
    s_add_u32 s36, s36, 1114112
    v_lshlrev_b32 v6, 4, v1
    v_mov_b32 v8, -1
    v_mov_b32 v9, -1
    v_mov_b32 v10, -1
    v_mov_b32 v11, -1
    buffer_store_dwordx4 v[8:11], v6, s[28:31], s36 offen sc1
    buffer_store_dwordx4 v[8:11], v6, s[28:31], s36 offen offset:1024 sc1
    v_mov_b32 v12, 0
    buffer_load_dword v12, v12, s[28:31], 0 offen offset:0 sc1
    v_mov_b32 v13, 0
    buffer_load_dword v13, v13, s[24:27], s38 offen
    s_mov_b32 s44, 0x7060500
    s_mov_b32 s45, 0x7060501
    s_mov_b32 s46, 0x7060502
    s_mov_b32 s47, 0x7060503
    s_mov_b32 s48, 0x0c0c0400
    s_mov_b32 s49, 0x04000c0c
    s_mov_b32 s50, 0xffffff00
    s_waitcnt vmcnt(0)
    v_readfirstlane_b32 s41, v12
    s_nop 3
    s_mul_i32 s40, s41, 0x9E3779B1
    s_add_u32 s40, s40, 0x7F4A7C15
    v_mov_b32 v8, s40
    v_mov_b32 v9, s40
    v_mov_b32 v10, s40
    v_mov_b32 v11, s40
    s_lshl_b32 s36, s37, 9
    s_lshl_b32 s39, s19, 4
    s_add_u32 s36, s36, s39
    s_add_u32 s36, s36, 4096
    v_mov_b32 v7, 0
    s_mov_b64 exec, 1
    buffer_store_dwordx4 v[8:11], v7, s[28:31], s36 offen sc1
    s_mov_b64 exec, -1
    s_barrier
    s_barrier
    s_cmp_eq_u32 s61, 3
    s_cbranch_scc1 L_svc_slow
    s_add_u32 s42, s38, 16384
    s_mov_b32 s43, 16384
    s_add_u32 m0, s43, 0
    s_add_u32 s39, s42, 0
    buffer_load_dwordx4 v4, s[24:27], s39 offen offset:0  lds
    buffer_load_dwordx4 v4, s[24:27], s39 offen offset:1024  lds
    buffer_load_dwordx4 v5, s[24:27], s39 offen offset:2048  lds
    buffer_load_dwordx4 v5, s[24:27], s39 offen offset:3072  lds
    s_add_u32 m0, s43, 4096
    s_add_u32 s39, s42, 4096
    buffer_load_dwordx4 v4, s[24:27], s39 offen offset:0  lds
    buffer_load_dwordx4 v4, s[24:27], s39 offen offset:1024  lds
    buffer_load_dwordx4 v5, s[24:27], s39 offen offset:2048  lds
    buffer_load_dwordx4 v5, s[24:27], s39 offen offset:3072  lds
    s_add_u32 s42, s38, 32768
    s_mov_b32 s43, 32768
    s_add_u32 m0, s43, 0
    s_add_u32 s39, s42, 0
    buffer_load_dwordx4 v4, s[24:27], s39 offen offset:0  lds
    buffer_load_dwordx4 v4, s[24:27], s39 offen offset:1024  lds
    buffer_load_dwordx4 v5, s[24:27], s39 offen offset:2048  lds
    buffer_load_dwordx4 v5, s[24:27], s39 offen offset:3072  lds
    s_add_u32 m0, s43, 4096
    s_add_u32 s39, s42, 4096
    buffer_load_dwordx4 v4, s[24:27], s39 offen offset:0  lds
    buffer_load_dwordx4 v4, s[24:27], s39 offen offset:1024  lds
    buffer_load_dwordx4 v5, s[24:27], s39 offen offset:2048  lds
    buffer_load_dwordx4 v5, s[24:27], s39 offen offset:3072  lds
    s_add_u32 s42, s38, 49152
    s_mov_b32 s43, 49152
    s_add_u32 m0, s43, 0
    s_add_u32 s39, s42, 0
    buffer_load_dwordx4 v4, s[24:27], s39 offen offset:0  lds
    buffer_load_dwordx4 v4, s[24:27], s39 offen offset:1024  lds
    buffer_load_dwordx4 v5, s[24:27], s39 offen offset:2048  lds
    buffer_load_dwordx4 v5, s[24:27], s39 offen offset:3072  lds
    s_add_u32 m0, s43, 4096
    s_add_u32 s39, s42, 4096
    buffer_load_dwordx4 v4, s[24:27], s39 offen offset:0  lds
    buffer_load_dwordx4 v4, s[24:27], s39 offen offset:1024  lds
    buffer_load_dwordx4 v5, s[24:27], s39 offen offset:2048  lds
    buffer_load_dwordx4 v5, s[24:27], s39 offen offset:3072  lds
    s_add_u32 s42, s38, 16384
    s_mov_b32 s43, 16384
    s_add_u32 m0, s43, 8192
    s_add_u32 s39, s42, 8192
    buffer_load_dwordx4 v4, s[24:27], s39 offen offset:0  lds
    buffer_load_dwordx4 v4, s[24:27], s39 offen offset:1024  lds
    buffer_load_dwordx4 v5, s[24:27], s39 offen offset:2048  lds
    buffer_load_dwordx4 v5, s[24:27], s39 offen offset:3072  lds
    s_add_u32 m0, s43, 12288
    s_add_u32 s39, s42, 12288
    buffer_load_dwordx4 v4, s[24:27], s39 offen offset:0  lds
    buffer_load_dwordx4 v4, s[24:27], s39 offen offset:1024  lds
    buffer_load_dwordx4 v5, s[24:27], s39 offen offset:2048  lds
    buffer_load_dwordx4 v5, s[24:27], s39 offen offset:3072  lds
    s_barrier
    s_add_u32 s42, s38, 32768
    s_mov_b32 s43, 32768
    s_add_u32 m0, s43, 8192
    s_add_u32 s39, s42, 8192
    buffer_load_dwordx4 v4, s[24:27], s39 offen offset:0  lds
    buffer_load_dwordx4 v4, s[24:27], s39 offen offset:1024  lds
    buffer_load_dwordx4 v5, s[24:27], s39 offen offset:2048  lds
    buffer_load_dwordx4 v5, s[24:27], s39 offen offset:3072  lds
    s_add_u32 m0, s43, 12288
    s_add_u32 s39, s42, 12288
    buffer_load_dwordx4 v4, s[24:27], s39 offen offset:0  lds
    buffer_load_dwordx4 v4, s[24:27], s39 offen offset:1024  lds
    buffer_load_dwordx4 v5, s[24:27], s39 offen offset:2048  lds
    buffer_load_dwordx4 v5, s[24:27], s39 offen offset:3072  lds
    s_add_u32 s42, s38, 49152
    s_mov_b32 s43, 49152
    s_add_u32 m0, s43, 8192
    s_add_u32 s39, s42, 8192
    buffer_load_dwordx4 v4, s[24:27], s39 offen offset:0  lds
    buffer_load_dwordx4 v4, s[24:27], s39 offen offset:1024  lds
    buffer_load_dwordx4 v5, s[24:27], s39 offen offset:2048  lds
    buffer_load_dwordx4 v5, s[24:27], s39 offen offset:3072  lds
    s_add_u32 m0, s43, 12288
    s_add_u32 s39, s42, 12288
    buffer_load_dwordx4 v4, s[24:27], s39 offen offset:0  lds
    buffer_load_dwordx4 v4, s[24:27], s39 offen offset:1024  lds
    buffer_load_dwordx4 v5, s[24:27], s39 offen offset:2048  lds
    buffer_load_dwordx4 v5, s[24:27], s39 offen offset:3072  lds
    s_add_u32 s42, s38, 65536
    s_mov_b32 s43, 65536
    s_add_u32 m0, s43, 0
    s_add_u32 s39, s42, 0
    buffer_load_dwordx4 v4, s[24:27], s39 offen offset:0  lds
    buffer_load_dwordx4 v4, s[24:27], s39 offen offset:1024  lds
    buffer_load_dwordx4 v5, s[24:27], s39 offen offset:2048  lds
    buffer_load_dwordx4 v5, s[24:27], s39 offen offset:3072  lds
    s_add_u32 m0, s43, 4096
    s_add_u32 s39, s42, 4096
    buffer_load_dwordx4 v4, s[24:27], s39 offen offset:0  lds
    buffer_load_dwordx4 v4, s[24:27], s39 offen offset:1024  lds
    buffer_load_dwordx4 v5, s[24:27], s39 offen offset:2048  lds
    buffer_load_dwordx4 v5, s[24:27], s39 offen offset:3072  lds
    s_add_u32 s42, s38, 81920
    s_mov_b32 s43, 81920
    s_add_u32 m0, s43, 0
    s_add_u32 s39, s42, 0
    buffer_load_dwordx4 v4, s[24:27], s39 offen offset:0  lds
    buffer_load_dwordx4 v4, s[24:27], s39 offen offset:1024  lds
    buffer_load_dwordx4 v5, s[24:27], s39 offen offset:2048  lds
    buffer_load_dwordx4 v5, s[24:27], s39 offen offset:3072  lds
    s_add_u32 m0, s43, 4096
    s_add_u32 s39, s42, 4096
    buffer_load_dwordx4 v4, s[24:27], s39 offen offset:0  lds
    buffer_load_dwordx4 v4, s[24:27], s39 offen offset:1024  lds
    buffer_load_dwordx4 v5, s[24:27], s39 offen offset:2048  lds
    buffer_load_dwordx4 v5, s[24:27], s39 offen offset:3072  lds
    s_add_u32 s42, s38, 98304
    s_mov_b32 s43, 98304
    s_add_u32 m0, s43, 0
    s_add_u32 s39, s42, 0
    buffer_load_dwordx4 v4, s[24:27], s39 offen offset:0  lds
    buffer_load_dwordx4 v4, s[24:27], s39 offen offset:1024  lds
    buffer_load_dwordx4 v5, s[24:27], s39 offen offset:2048  lds
    buffer_load_dwordx4 v5, s[24:27], s39 offen offset:3072  lds
    s_add_u32 m0, s43, 4096
    s_add_u32 s39, s42, 4096
    buffer_load_dwordx4 v4, s[24:27], s39 offen offset:0  lds
    buffer_load_dwordx4 v4, s[24:27], s39 offen offset:1024  lds
    buffer_load_dwordx4 v5, s[24:27], s39 offen offset:2048  lds
    buffer_load_dwordx4 v5, s[24:27], s39 offen offset:3072  lds
    s_add_u32 s42, s38, 114688
    s_mov_b32 s43, 114688
    s_add_u32 m0, s43, 0
    s_add_u32 s39, s42, 0
    buffer_load_dwordx4 v4, s[24:27], s39 offen offset:0  lds
    buffer_load_dwordx4 v4, s[24:27], s39 offen offset:1024  lds
    buffer_load_dwordx4 v5, s[24:27], s39 offen offset:2048  lds
    buffer_load_dwordx4 v5, s[24:27], s39 offen offset:3072  lds
    s_add_u32 m0, s43, 4096
    s_add_u32 s39, s42, 4096
    buffer_load_dwordx4 v4, s[24:27], s39 offen offset:0  lds
    buffer_load_dwordx4 v4, s[24:27], s39 offen offset:1024  lds
    buffer_load_dwordx4 v5, s[24:27], s39 offen offset:2048  lds
    buffer_load_dwordx4 v5, s[24:27], s39 offen offset:3072  lds
    s_waitcnt vmcnt(32)
    s_barrier
    s_add_u32 s42, s38, 65536
    s_mov_b32 s43, 65536
    s_add_u32 m0, s43, 8192
    s_add_u32 s39, s42, 8192
    buffer_load_dwordx4 v4, s[24:27], s39 offen offset:0  lds
    buffer_load_dwordx4 v4, s[24:27], s39 offen offset:1024  lds
    buffer_load_dwordx4 v5, s[24:27], s39 offen offset:2048  lds
    buffer_load_dwordx4 v5, s[24:27], s39 offen offset:3072  lds
    s_add_u32 m0, s43, 12288
    s_add_u32 s39, s42, 12288
    buffer_load_dwordx4 v4, s[24:27], s39 offen offset:0  lds
    buffer_load_dwordx4 v4, s[24:27], s39 offen offset:1024  lds
    buffer_load_dwordx4 v5, s[24:27], s39 offen offset:2048  lds
    buffer_load_dwordx4 v5, s[24:27], s39 offen offset:3072  lds
    s_add_u32 s42, s38, 81920
    s_mov_b32 s43, 81920
    s_add_u32 m0, s43, 8192
    s_add_u32 s39, s42, 8192
    buffer_load_dwordx4 v4, s[24:27], s39 offen offset:0  lds
    buffer_load_dwordx4 v4, s[24:27], s39 offen offset:1024  lds
    buffer_load_dwordx4 v5, s[24:27], s39 offen offset:2048  lds
    buffer_load_dwordx4 v5, s[24:27], s39 offen offset:3072  lds
    s_add_u32 m0, s43, 12288
    s_add_u32 s39, s42, 12288
    buffer_load_dwordx4 v4, s[24:27], s39 offen offset:0  lds
    buffer_load_dwordx4 v4, s[24:27], s39 offen offset:1024  lds
    buffer_load_dwordx4 v5, s[24:27], s39 offen offset:2048  lds
    buffer_load_dwordx4 v5, s[24:27], s39 offen offset:3072  lds
    s_add_u32 s42, s38, 98304
    s_mov_b32 s43, 98304
    s_add_u32 m0, s43, 8192
    s_add_u32 s39, s42, 8192
    buffer_load_dwordx4 v4, s[24:27], s39 offen offset:0  lds
    buffer_load_dwordx4 v4, s[24:27], s39 offen offset:1024  lds
    buffer_load_dwordx4 v5, s[24:27], s39 offen offset:2048  lds
    buffer_load_dwordx4 v5, s[24:27], s39 offen offset:3072  lds
    s_add_u32 m0, s43, 12288
    s_add_u32 s39, s42, 12288
    buffer_load_dwordx4 v4, s[24:27], s39 offen offset:0  lds
    buffer_load_dwordx4 v4, s[24:27], s39 offen offset:1024  lds
    buffer_load_dwordx4 v5, s[24:27], s39 offen offset:2048  lds
    buffer_load_dwordx4 v5, s[24:27], s39 offen offset:3072  lds
    s_add_u32 s42, s38, 114688
    s_mov_b32 s43, 114688
    s_add_u32 m0, s43, 8192
    s_add_u32 s39, s42, 8192
    buffer_load_dwordx4 v4, s[24:27], s39 offen offset:0  lds
    buffer_load_dwordx4 v4, s[24:27], s39 offen offset:1024  lds
    buffer_load_dwordx4 v5, s[24:27], s39 offen offset:2048  lds
    buffer_load_dwordx4 v5, s[24:27], s39 offen offset:3072  lds
    s_add_u32 m0, s43, 12288
    s_add_u32 s39, s42, 12288
    buffer_load_dwordx4 v4, s[24:27], s39 offen offset:0  lds
    buffer_load_dwordx4 v4, s[24:27], s39 offen offset:1024  lds
    buffer_load_dwordx4 v5, s[24:27], s39 offen offset:2048  lds
    buffer_load_dwordx4 v5, s[24:27], s39 offen offset:3072  lds
    s_waitcnt vmcnt(32)
    s_barrier
    s_waitcnt vmcnt(0)
    s_barrier
    s_branch L_svc_done
L_svc_slow:
    s_add_u32 s42, s38, 49152
    s_mov_b32 s43, 49152
    s_add_u32 m0, s43, 0
    s_add_u32 s39, s42, 0
    buffer_load_dwordx4 v4, s[24:27], s39 offen offset:0  lds
    buffer_load_dwordx4 v4, s[24:27], s39 offen offset:1024  lds
    buffer_load_dwordx4 v5, s[24:27], s39 offen offset:2048  lds
    buffer_load_dwordx4 v5, s[24:27], s39 offen offset:3072  lds
    s_add_u32 m0, s43, 4096
    s_add_u32 s39, s42, 4096
    buffer_load_dwordx4 v4, s[24:27], s39 offen offset:0  lds
    buffer_load_dwordx4 v4, s[24:27], s39 offen offset:1024  lds
    buffer_load_dwordx4 v5, s[24:27], s39 offen offset:2048  lds
    buffer_load_dwordx4 v5, s[24:27], s39 offen offset:3072  lds
    s_add_u32 s42, s38, 49152
    s_mov_b32 s43, 49152
    s_add_u32 m0, s43, 8192
    s_add_u32 s39, s42, 8192
    buffer_load_dwordx4 v4, s[24:27], s39 offen offset:0  lds
    buffer_load_dwordx4 v4, s[24:27], s39 offen offset:1024  lds
    buffer_load_dwordx4 v5, s[24:27], s39 offen offset:2048  lds
    buffer_load_dwordx4 v5, s[24:27], s39 offen offset:3072  lds
    s_add_u32 m0, s43, 12288
    s_add_u32 s39, s42, 12288
    buffer_load_dwordx4 v4, s[24:27], s39 offen offset:0  lds
    buffer_load_dwordx4 v4, s[24:27], s39 offen offset:1024  lds
    buffer_load_dwordx4 v5, s[24:27], s39 offen offset:2048  lds
    buffer_load_dwordx4 v5, s[24:27], s39 offen offset:3072  lds
    s_add_u32 s42, s38, 65536
    s_mov_b32 s43, 65536
    s_add_u32 m0, s43, 0
    s_add_u32 s39, s42, 0
    buffer_load_dwordx4 v4, s[24:27], s39 offen offset:0  lds
    buffer_load_dwordx4 v4, s[24:27], s39 offen offset:1024  lds
    buffer_load_dwordx4 v5, s[24:27], s39 offen offset:2048  lds
    buffer_load_dwordx4 v5, s[24:27], s39 offen offset:3072  lds
    s_add_u32 m0, s43, 4096
    s_add_u32 s39, s42, 4096
    buffer_load_dwordx4 v4, s[24:27], s39 offen offset:0  lds
    buffer_load_dwordx4 v4, s[24:27], s39 offen offset:1024  lds
    buffer_load_dwordx4 v5, s[24:27], s39 offen offset:2048  lds
    buffer_load_dwordx4 v5, s[24:27], s39 offen offset:3072  lds
    s_add_u32 s42, s38, 81920
    s_mov_b32 s43, 81920
    s_add_u32 m0, s43, 0
    s_add_u32 s39, s42, 0
    buffer_load_dwordx4 v4, s[24:27], s39 offen offset:0  lds
    buffer_load_dwordx4 v4, s[24:27], s39 offen offset:1024  lds
    buffer_load_dwordx4 v5, s[24:27], s39 offen offset:2048  lds
    buffer_load_dwordx4 v5, s[24:27], s39 offen offset:3072  lds
    s_add_u32 m0, s43, 4096
    s_add_u32 s39, s42, 4096
    buffer_load_dwordx4 v4, s[24:27], s39 offen offset:0  lds
    buffer_load_dwordx4 v4, s[24:27], s39 offen offset:1024  lds
    buffer_load_dwordx4 v5, s[24:27], s39 offen offset:2048  lds
    buffer_load_dwordx4 v5, s[24:27], s39 offen offset:3072  lds
    s_barrier
    s_add_u32 s42, s38, 98304
    s_mov_b32 s43, 98304
    s_add_u32 m0, s43, 0
    s_add_u32 s39, s42, 0
    buffer_load_dwordx4 v4, s[24:27], s39 offen offset:0  lds
    buffer_load_dwordx4 v4, s[24:27], s39 offen offset:1024  lds
    buffer_load_dwordx4 v5, s[24:27], s39 offen offset:2048  lds
    buffer_load_dwordx4 v5, s[24:27], s39 offen offset:3072  lds
    s_add_u32 m0, s43, 4096
    s_add_u32 s39, s42, 4096
    buffer_load_dwordx4 v4, s[24:27], s39 offen offset:0  lds
    buffer_load_dwordx4 v4, s[24:27], s39 offen offset:1024  lds
    buffer_load_dwordx4 v5, s[24:27], s39 offen offset:2048  lds
    buffer_load_dwordx4 v5, s[24:27], s39 offen offset:3072  lds
    s_add_u32 s42, s38, 114688
    s_mov_b32 s43, 114688
    s_add_u32 m0, s43, 0
    s_add_u32 s39, s42, 0
    buffer_load_dwordx4 v4, s[24:27], s39 offen offset:0  lds
    buffer_load_dwordx4 v4, s[24:27], s39 offen offset:1024  lds
    buffer_load_dwordx4 v5, s[24:27], s39 offen offset:2048  lds
    buffer_load_dwordx4 v5, s[24:27], s39 offen offset:3072  lds
    s_add_u32 m0, s43, 4096
    s_add_u32 s39, s42, 4096
    buffer_load_dwordx4 v4, s[24:27], s39 offen offset:0  lds
    buffer_load_dwordx4 v4, s[24:27], s39 offen offset:1024  lds
    buffer_load_dwordx4 v5, s[24:27], s39 offen offset:2048  lds
    buffer_load_dwordx4 v5, s[24:27], s39 offen offset:3072  lds
    s_waitcnt vmcnt(32)
    s_barrier
    s_add_u32 s42, s38, 65536
    s_mov_b32 s43, 65536
    s_add_u32 m0, s43, 8192
    s_add_u32 s39, s42, 8192
    buffer_load_dwordx4 v4, s[24:27], s39 offen offset:0  lds
    buffer_load_dwordx4 v4, s[24:27], s39 offen offset:1024  lds
    buffer_load_dwordx4 v5, s[24:27], s39 offen offset:2048  lds
    buffer_load_dwordx4 v5, s[24:27], s39 offen offset:3072  lds
    s_add_u32 m0, s43, 12288
    s_add_u32 s39, s42, 12288
    buffer_load_dwordx4 v4, s[24:27], s39 offen offset:0  lds
    buffer_load_dwordx4 v4, s[24:27], s39 offen offset:1024  lds
    buffer_load_dwordx4 v5, s[24:27], s39 offen offset:2048  lds
    buffer_load_dwordx4 v5, s[24:27], s39 offen offset:3072  lds
    s_add_u32 s42, s38, 81920
    s_mov_b32 s43, 81920
    s_add_u32 m0, s43, 8192
    s_add_u32 s39, s42, 8192
    buffer_load_dwordx4 v4, s[24:27], s39 offen offset:0  lds
    buffer_load_dwordx4 v4, s[24:27], s39 offen offset:1024  lds
    buffer_load_dwordx4 v5, s[24:27], s39 offen offset:2048  lds
    buffer_load_dwordx4 v5, s[24:27], s39 offen offset:3072  lds
    s_add_u32 m0, s43, 12288
    s_add_u32 s39, s42, 12288
    buffer_load_dwordx4 v4, s[24:27], s39 offen offset:0  lds
    buffer_load_dwordx4 v4, s[24:27], s39 offen offset:1024  lds
    buffer_load_dwordx4 v5, s[24:27], s39 offen offset:2048  lds
    buffer_load_dwordx4 v5, s[24:27], s39 offen offset:3072  lds
    s_add_u32 s42, s38, 98304
    s_mov_b32 s43, 98304
    s_add_u32 m0, s43, 8192
    s_add_u32 s39, s42, 8192
    buffer_load_dwordx4 v4, s[24:27], s39 offen offset:0  lds
    buffer_load_dwordx4 v4, s[24:27], s39 offen offset:1024  lds
    buffer_load_dwordx4 v5, s[24:27], s39 offen offset:2048  lds
    buffer_load_dwordx4 v5, s[24:27], s39 offen offset:3072  lds
    s_add_u32 m0, s43, 12288
    s_add_u32 s39, s42, 12288
    buffer_load_dwordx4 v4, s[24:27], s39 offen offset:0  lds
    buffer_load_dwordx4 v4, s[24:27], s39 offen offset:1024  lds
    buffer_load_dwordx4 v5, s[24:27], s39 offen offset:2048  lds
    buffer_load_dwordx4 v5, s[24:27], s39 offen offset:3072  lds
    s_add_u32 s42, s38, 114688
    s_mov_b32 s43, 114688
    s_add_u32 m0, s43, 8192
    s_add_u32 s39, s42, 8192
    buffer_load_dwordx4 v4, s[24:27], s39 offen offset:0  lds
    buffer_load_dwordx4 v4, s[24:27], s39 offen offset:1024  lds
    buffer_load_dwordx4 v5, s[24:27], s39 offen offset:2048  lds
    buffer_load_dwordx4 v5, s[24:27], s39 offen offset:3072  lds
    s_add_u32 m0, s43, 12288
    s_add_u32 s39, s42, 12288
    buffer_load_dwordx4 v4, s[24:27], s39 offen offset:0  lds
    buffer_load_dwordx4 v4, s[24:27], s39 offen offset:1024  lds
    buffer_load_dwordx4 v5, s[24:27], s39 offen offset:2048  lds
    buffer_load_dwordx4 v5, s[24:27], s39 offen offset:3072  lds
    s_waitcnt vmcnt(32)
    s_barrier
    s_waitcnt vmcnt(0)
    s_barrier
L_svc_done:
L_end:
    s_endpgm
L_code_end:
.section .rodata,"a"
.p2align 6
  .amdhsa_kernel standalone__sliding_block_cached__sampling_kernel
  .amdhsa_next_free_vgpr 168
  .amdhsa_next_free_sgpr 102
  .amdhsa_accum_offset 168
  .amdhsa_group_segment_fixed_size 0
  .amdhsa_kernarg_size 64
  .amdhsa_user_sgpr_count 2
  .amdhsa_user_sgpr_kernarg_segment_ptr 1
  .amdhsa_system_sgpr_workgroup_id_x 1
  .amdhsa_float_denorm_mode_32 3
.end_amdhsa_kernel
```
